```python
import torch

def _softmax(x, axis=-1):
    return torch.softmax(x, dim=axis)
def _gelu(x):
    return torch.nn.functional.gelu(x, approximate="tanh")
def _silu(x):
    return torch.nn.functional.silu(x)
def _sigmoid(x):
    return torch.sigmoid(x)
def _layernorm(x, axis=-1, eps=1e-5):
    m = x.mean(dim=axis, keepdim=True)
    v = x.var(dim=axis, keepdim=True, unbiased=False)
    return (x - m) / torch.sqrt(v + eps)
def _scatter_add(tgt, idx, src, axis=0):
    return tgt.clone().index_add_(axis, idx, src)
def _segment_sum(src, seg, n):
    out = torch.zeros((n,) + src.shape[1:], dtype=src.dtype)
    return out.index_add_(0, seg, src)
def _pad(x, pw):
    flat = tuple(v for pair in reversed(pw) for v in pair)
    return torch.nn.functional.pad(x, flat)

kernel_name = 'sequential_preLN__sliding_local_dilated__mixer_s_mlp__prompt'

def setup_inputs():

    _w = (lambda a: (lambda t: t.to(torch.bfloat16) if t.is_floating_point() else t)(torch.as_tensor(a)))
    def _A_setup():
        B, S, D = 1, 2048, 512
        return {
            "x": _w((lambda *s: torch.randn(*s, dtype=torch.bfloat16) * 0.05)(B, S, D)),
            "wqkv": _w((lambda *s: torch.randn(*s, dtype=torch.bfloat16) * 0.05)(D, 3 * D)),
            "wo": _w((lambda *s: torch.randn(*s, dtype=torch.bfloat16) * 0.05)(D, D)),
        }
    _A_in = _A_setup()

    def _B_setup():
        B, S, D, F = 1, 2048, 512, 1792
        return {
            "x":  _w((lambda *s: torch.randn(*s, dtype=torch.bfloat16) * 0.05)(B, S, D)),
            "w1": _w((lambda *s: torch.randn(*s, dtype=torch.bfloat16) * 3.2)(D, D) * (D ** -0.5)),
            "w2": _w((lambda *s: torch.randn(*s, dtype=torch.bfloat16) * 3.2)(D, D) * (D ** -0.5)),
            "w3": _w((lambda *s: torch.randn(*s, dtype=torch.bfloat16) * 3.2)(D, F) * (D ** -0.5)),
            "w4": _w((lambda *s: torch.randn(*s, dtype=torch.bfloat16) * 3.2)(F, D) * (F ** -0.5)),
        }
    _B_in = _B_setup()

    return {
        "A_x": _A_in["x"],
        "A_wqkv": _A_in["wqkv"],
        "A_wo": _A_in["wo"],
        "B_x": _B_in["x"],
        "B_w1": _B_in["w1"],
        "B_w2": _B_in["w2"],
        "B_w3": _B_in["w3"],
        "B_w4": _B_in["w4"],
    }

def reference(A_x, A_wqkv, A_wo, B_x, B_w1, B_w2, B_w3, B_w4):
    def _A_ref(x, wqkv, wo):
        B, S, D = x.shape
        H = 32; Dh = D // H
        W, dil = 8, 2
        qkv = (lambda x, *d: x.permute(*d))((x @ wqkv).reshape(B, S, 3, H, Dh), 2, 0, 3, 1, 4)
        q, k, v = qkv[0], qkv[1], qkv[2]
        scale = Dh ** -0.5
        pos = torch.arange(S)
        off = torch.arange(W) * dil
        idx = pos[:, None] - off[None, :]
        mask = idx >= 0
        idx_c = torch.where(mask, idx, 0).reshape(-1)
        kg = k[:, :, idx_c, :].reshape(B, H, S, W, Dh)
        vg = v[:, :, idx_c, :].reshape(B, H, S, W, Dh)
        logits = torch.einsum("bhsd,bhswd->bhsw", q, kg) * scale
        logits = torch.where(mask[None, None, :, :], logits, -1e9)
        attn = _softmax(logits, axis=-1)
        o = torch.einsum("bhsw,bhswd->bhsd", attn, vg)
        return (lambda x, *d: x.permute(*d))(o, 0, 2, 1, 3).reshape(B, S, D) @ wo

    def _B_ref(x, w1, w2, w3, w4):
        B, S, D = x.shape
        h = _gelu(_layernorm(x, axis=-1) @ w1)
        c = D // 4
        g0 = _pad(h[:, :, 0*c:1*c], ((0, 0), (1, 0), (0, 0)))[:, :S, :]
        g1 = _pad(h[:, :, 1*c:2*c], ((0, 0), (0, 1), (0, 0)))[:, 1:, :]
        g2 = _pad(h[:, :, 2*c:3*c], ((0, 0), (2, 0), (0, 0)))[:, :S, :]
        g3 = _pad(h[:, :, 3*c:   ], ((0, 0), (0, 2), (0, 0)))[:, 2:, :]
        hs = torch.concatenate([g0, g1, g2, g3], axis=-1) @ w2
        x1 = x + hs
        h2 = _gelu(_layernorm(x1, axis=-1) @ w3) @ w4
        return x1 + h2

    x = A_x
    h = x + _A_ref(_layernorm(x, axis=-1), A_wqkv, A_wo)
    h2 = h + _B_ref(_layernorm(h, axis=-1), B_w1, B_w2, B_w3, B_w4)
    return h2
```

```asm
; @launch grid=(256,1,1) block=(512,1,1) lds=163840
.amdgcn_target "amdgcn-amd-amdhsa--gfx950"
.text
.globl sequential_preLN__sliding_local_dilated__mixer_s_mlp__prompt_kernel
.p2align 8
.type sequential_preLN__sliding_local_dilated__mixer_s_mlp__prompt_kernel,@function
sequential_preLN__sliding_local_dilated__mixer_s_mlp__prompt_kernel:
    s_getpc_b64 s[68:69]
L_pc:
    s_load_dwordx2 s[16:17], s[0:1], 0
    s_cmp_ge_u32 s2, 32
    s_cbranch_scc1 L_nocp
    v_lshlrev_b32 v1, 7, v0
    v_min_u32 v1, L_end-L_pc, v1
    global_load_dword v255, v1, s[68:69]
L_nocp:
    s_cmp_ge_u32 s2, 256
    s_cbranch_scc1 L_end
    s_load_dwordx2 s[18:19], s[0:1], 8
    s_load_dwordx4 s[20:23], s[0:1], 16
    s_load_dwordx8 s[24:31], s[0:1], 32
    s_load_dwordx4 s[32:35], s[0:1], 64
    s_load_dwordx2 s[36:37], s[0:1], 80
    v_lshrrev_b32 v1, 6, v0
    v_and_b32 v0, 63, v0
    v_readfirstlane_b32 s3, v1
    s_and_b32 s65, s2, 1
    s_lshr_b32 s64, s2, 3
    s_and_b32 s38, s64, 3
    s_lshl_b32 s44, s65, 2
    s_add_u32 s38, s38, s44
    s_and_b32 s39, s2, 6
    s_lshl_b32 s39, s39, 2
    s_lshr_b32 s45, s64, 2
    s_add_u32 s39, s39, s45
    s_mov_b32 s42, 0x80000
    s_and_b32 s67, s3, 1
    s_lshl_b32 s61, s67, 16
    v_mov_b32 v7, 163584
    v_lshlrev_b32 v10, 4, v0
    v_lshrrev_b32 v1, 4, v0
    v_and_b32 v2, 15, v0
    s_mov_b32 s10, 18874368
    s_mov_b32 s11, 0x00020000
    s_mov_b32 s7, 0x00020000
    s_mov_b32 s15, 0x00020000
    s_mov_b32 s52, 0x3f803f80
    s_cmp_ge_u32 s3, 4
    s_cbranch_scc1 L_service
    s_lshl_b32 s41, s39, 2
    s_add_u32 s41, s41, s3
    s_lshr_b32 s40, s41, 1
    s_mov_b32 s6, 2097152
    s_lshl_b32 s46, s40, 15
    s_lshl_b32 s44, s67, 8
    s_add_u32 s46, s46, s44
    s_lshr_b32 s47, s3, 1
    s_lshl_b32 s47, s47, 14
    s_add_u32 s47, s47, s61
    s_add_u32 s47, s47, 32768
    s_mov_b32 m0, s47
    v_lshrrev_b32 v3, 5, v0
    v_xor_b32 v4, v2, v3
    v_lshlrev_b32 v4, 4, v4
    v_lshl_add_u32 v4, v3, 10, v4
    v_and_b32 v5, 1, v1
    v_lshl_add_u32 v128, v5, 9, v4
    v_xor_b32 v129, 32, v128
    v_xor_b32 v130, 64, v128
    v_xor_b32 v131, 96, v128
    v_xor_b32 v132, 128, v128
    v_xor_b32 v133, 160, v128
    v_xor_b32 v134, 192, v128
    v_xor_b32 v135, 224, v128
    s_waitcnt lgkmcnt(0)
    s_mov_b32 s4, s16
    s_mov_b32 s5, s17
    buffer_load_dwordx4 v128, s[4:7], s46 offen lds
    s_add_u32 m0, m0, 1024
    s_add_u32 s46, s46, 2048
    buffer_load_dwordx4 v129, s[4:7], s46 offen lds
    s_add_u32 m0, m0, 1024
    s_add_u32 s46, s46, 2048
    buffer_load_dwordx4 v130, s[4:7], s46 offen lds
    s_add_u32 m0, m0, 1024
    s_add_u32 s46, s46, 2048
    buffer_load_dwordx4 v131, s[4:7], s46 offen lds
    s_add_u32 m0, m0, 1024
    s_add_u32 s46, s46, 2048
    buffer_load_dwordx4 v132, s[4:7], s46 offen lds
    s_add_u32 m0, m0, 1024
    s_add_u32 s46, s46, 2048
    buffer_load_dwordx4 v133, s[4:7], s46 offen lds
    s_add_u32 m0, m0, 1024
    s_add_u32 s46, s46, 2048
    buffer_load_dwordx4 v134, s[4:7], s46 offen lds
    s_add_u32 m0, m0, 1024
    s_add_u32 s46, s46, 2048
    buffer_load_dwordx4 v135, s[4:7], s46 offen lds
    s_add_u32 m0, m0, 1024
    s_add_u32 s46, s46, 2048
    buffer_load_dwordx4 v128, s[4:7], s46 offen lds
    s_add_u32 m0, m0, 1024
    s_add_u32 s46, s46, 2048
    buffer_load_dwordx4 v129, s[4:7], s46 offen lds
    s_add_u32 m0, m0, 1024
    s_add_u32 s46, s46, 2048
    buffer_load_dwordx4 v130, s[4:7], s46 offen lds
    s_add_u32 m0, m0, 1024
    s_add_u32 s46, s46, 2048
    buffer_load_dwordx4 v131, s[4:7], s46 offen lds
    s_add_u32 m0, m0, 1024
    s_add_u32 s46, s46, 2048
    buffer_load_dwordx4 v132, s[4:7], s46 offen lds
    s_add_u32 m0, m0, 1024
    s_add_u32 s46, s46, 2048
    buffer_load_dwordx4 v133, s[4:7], s46 offen lds
    s_add_u32 m0, m0, 1024
    s_add_u32 s46, s46, 2048
    buffer_load_dwordx4 v134, s[4:7], s46 offen lds
    s_add_u32 m0, m0, 1024
    s_add_u32 s46, s46, 2048
    buffer_load_dwordx4 v135, s[4:7], s46 offen lds
    s_barrier
    s_mov_b32 s8, s36
    s_mov_b32 s9, s37
    s_mov_b32 s12, s32
    s_mov_b32 s13, s33
    s_mov_b32 s14, 2097152
    s_mov_b32 s53, 0x3eb8aa3b
    s_mov_b32 s58, 0xaaaaaaaa
    s_mov_b32 s59, 0xaaaaaaaa
    s_mov_b32 s76, 1.0
    s_mov_b32 s77, 1.0
    s_mov_b64 vcc, 0
    v_lshrrev_b32 v4, 2, v0
    v_bfe_u32 v5, v4, 1, 2
    v_lshlrev_b32 v5, 5, v5
    v_and_b32 v3, 3, v0
    v_lshl_add_u32 v5, v3, 3, v5
    v_lshl_add_u32 v12, v4, 7, v5
    v_xor_b32 v13, 32, v12
    v_xor_b32 v14, 64, v12
    v_xor_b32 v15, 96, v12
    v_and_b32 v5, 1, v1
    v_lshlrev_b32 v5, 5, v5
    v_lshl_add_u32 v5, v3, 3, v5
    v_lshl_add_u32 v20, v4, 6, v5
    v_xor_b32 v21, 32, v20
    v_add_u32 v16, s61, v12
    v_add_u32 v17, s61, v13
    v_add_u32 v18, s61, v14
    v_add_u32 v19, s61, v15
    v_lshlrev_b32 v246, 4, v1
    v_add_u32 v246, 162816, v246
    s_lshl_b32 s46, s3, 12
    s_add_u32 s46, s46, 131072
    v_add_u32 v28, s46, v10
    v_xor_b32 v29, 0x1000, v28
    v_cmp_eq_u32 s[68:69], 0, v0
    v_cmp_gt_u32 s[70:71], 16, v0
    v_mov_b32 v3, 1073741824
    s_lshl_b32 s63, s40, 7
    s_add_u32 s63, s63, 15990784
    v_cndmask_b32 v11, v3, 0, s[68:69]
    s_lshl_b32 s44, s41, 10
    s_lshr_b32 s45, s38, 1
    s_lshl_b32 s45, s45, 8
    s_add_u32 s44, s44, s45
    s_and_b32 s45, s38, 1
    s_lshl_b32 s45, s45, 3
    s_add_u32 s44, s44, s45
    v_add_u32 v4, s44, v10
    v_cndmask_b32 v26, v3, v4, s[70:71]
    s_lshl_b32 s44, s39, 3
    s_add_u32 s44, s44, s38
    s_lshl_b32 s54, s44, 7
    s_add_u32 s54, s54, 15998976
    s_lshl_b32 s66, s44, 12
    s_add_u32 s66, s66, 16777216
    s_lshl_b32 s62, s41, 14
    s_lshl_b32 s45, s38, 11
    s_add_u32 s62, s62, s45
    s_lshl_b32 s45, s38, 7
    s_lshl_b32 s84, s41, 14
    s_add_u32 s84, s84, s45
    v_and_b32 v4, 1, v1
    v_lshlrev_b32 v4, 5, v4
    v_lshrrev_b32 v5, 1, v1
    v_lshl_add_u32 v4, v5, 4, v4
    v_lshl_add_u32 v27, v2, 10, v4
    v_add_u32 v27, s84, v27
    v_mov_b32 v30, 0xc0135761
    v_mov_b32 v242, 0xbdd2d3e8
    v_mov_b32 v31, 0xc0135761
    v_mov_b32 v243, 0xbdd2d3e8
    s_mul_i32 s44, s67, 20480
    s_mul_i32 s45, s67, -12288
    s_add_u32 s45, s45, 16384
    v_add_u32 v32, s44, v10
    v_add_u32 v33, s45, v10
    v_add_u32 v34, 0x2000, v32
    v_add_u32 v35, 0x2000, v33
    v_lshrrev_b32 v4, 1, v1
    v_xor_b32 v4, v4, v2
    v_lshlrev_b32 v4, 4, v4
    v_lshl_add_u32 v4, v2, 9, v4
    v_and_b32 v5, 1, v1
    v_lshl_add_u32 v4, v5, 3, v4
    s_lshl_b32 s44, s67, 13
    s_add_u32 s44, s44, s47
    v_add_u32 v192, s44, v4
    v_xor_b32 v193, 32, v192
    v_xor_b32 v194, 64, v192
    v_xor_b32 v195, 96, v192
    v_xor_b32 v196, 128, v192
    v_xor_b32 v197, 160, v192
    v_xor_b32 v198, 192, v192
    v_xor_b32 v199, 224, v192
    v_xor_b32 v200, 0x2000, v192
    v_xor_b32 v201, 0x2000, v193
    v_xor_b32 v202, 0x2000, v194
    v_xor_b32 v203, 0x2000, v195
    v_xor_b32 v204, 0x2000, v196
    v_xor_b32 v205, 0x2000, v197
    v_xor_b32 v206, 0x2000, v198
    v_xor_b32 v207, 0x2000, v199
    v_mov_b32 v60, 0
    v_mov_b32 v61, 0
    v_mov_b32 v62, 0
    v_mov_b32 v63, 0
    s_lshl_b32 s44, s3, 11
    s_add_u32 s44, s44, 154624
    v_lshl_add_u32 v3, v2, 4, s44
    s_lshl_b32 s44, s3, 2
    v_add_u32 v249, s44, v7
    v_mov_b32 v5, 196608
    v_cndmask_b32 v248, v5, v249, s[68:69]
    v_xor_b32 v249, 4, v249
    s_lshl_b32 s44, s38, 1
    s_add_u32 s44, s44, s67
    s_lshl_b32 s44, 1, s44
    v_mov_b32 v250, s44
    s_lshl_b32 s44, s44, 16
    v_mov_b32 v251, s44
    s_lshl_b32 s44, s67, 2
    s_lshl_b32 s91, 15, s44
    s_mov_b32 s89, 0
    s_mov_b32 s90, 0
    s_bfe_u32 s44, s38, 0x10001
    s_xor_b32 s44, s44, s67
    s_lshl_b32 s44, s44, 16
    s_and_b32 s45, s38, 1
    s_lshl_b32 s45, s45, 7
    s_or_b32 s44, s44, s45
    s_lshr_b32 s45, s38, 2
    s_lshl_b32 s45, s45, 8
    v_xor_b32 v232, s44, v192
    v_add_u32 v232, s45, v232
    v_xor_b32 v233, 32, v232
    v_xor_b32 v234, 64, v232
    v_xor_b32 v235, 96, v232
    s_lshr_b32 s44, s38, 2
    s_add_u32 s44, s44, 1
    s_sub_u32 s45, 0, s44
    s_bitcmp1_b32 s38, 1
    s_cselect_b32 s44, s45, s44
    s_lshl_b32 s45, s41, 4
    s_add_u32 s44, s44, s45
    s_movk_i32 s45, 0x800
    v_add_u32 v4, s44, v2
    v_cmp_gt_u32 s[70:71], s45, v4
    v_lshrrev_b32 v5, 4, v4
    v_lshlrev_b32 v5, 14, v5
    v_lshl_add_u32 v5, v1, 8, v5
    v_and_b32 v4, 15, v4
    v_lshl_add_u32 v5, v4, 4, v5
    v_mov_b32 v4, 1073741824
    v_cndmask_b32 v254, v4, v5, s[70:71]
    v_and_b32 v4, 1, v2
    v_lshl_add_u32 v4, v1, 2, v4
    v_sub_u32 v4, v2, v4
    v_mov_b32 v8, 0xf149f2ca
    s_cmp_eq_u32 s41, 0
    s_cselect_b32 s44, -64, 16
    v_add_u32 v5, -2, v4
    v_cmp_gt_u32 s[68:69], 15, v4
    v_cmp_gt_u32 s[70:71], 15, v5
    v_add_u32 v4, s44, v4
    v_add_u32 v5, -2, v4
    v_cndmask_b32 v54, v8, 0, s[68:69]
    v_cndmask_b32 v55, v8, 0, s[70:71]
    v_cmp_gt_u32 s[68:69], 15, v4
    v_cmp_gt_u32 s[70:71], 15, v5
    v_mov_b32 v4, 0x0c0c0100
    v_mov_b32 v5, 0x01000c0c
    v_cndmask_b32 v56, v8, 0, s[68:69]
    v_cndmask_b32 v57, v8, 0, s[70:71]
    v_cndmask_b32 v58, v4, v5, s[58:59]
    v_mov_b32 v4, 0x0c0c0302
    v_mov_b32 v5, 0x03020c0c
    v_cndmask_b32 v59, v4, v5, s[58:59]
    s_waitcnt vmcnt(0)
    ds_read_b64 v[64:65], v192 offset:0
    ds_read_b64 v[66:67], v193 offset:0
    ds_read_b64 v[68:69], v200 offset:0
    ds_read_b64 v[70:71], v201 offset:0
    ds_read_b64 v[72:73], v194 offset:0
    ds_read_b64 v[74:75], v195 offset:0
    ds_read_b64 v[76:77], v202 offset:0
    ds_read_b64 v[78:79], v203 offset:0
    ds_read_b64 v[80:81], v196 offset:0
    ds_read_b64 v[82:83], v197 offset:0
    ds_read_b64 v[84:85], v204 offset:0
    ds_read_b64 v[86:87], v205 offset:0
    ds_read_b64 v[88:89], v198 offset:0
    ds_read_b64 v[90:91], v199 offset:0
    ds_read_b64 v[92:93], v206 offset:0
    ds_read_b64 v[94:95], v207 offset:0
    ds_read_b64 v[96:97], v192 offset:256
    ds_read_b64 v[98:99], v193 offset:256
    ds_read_b64 v[100:101], v200 offset:256
    ds_read_b64 v[102:103], v201 offset:256
    ds_read_b64 v[104:105], v194 offset:256
    ds_read_b64 v[106:107], v195 offset:256
    ds_read_b64 v[108:109], v202 offset:256
    ds_read_b64 v[110:111], v203 offset:256
    ds_read_b64 v[112:113], v196 offset:256
    ds_read_b64 v[114:115], v197 offset:256
    ds_read_b64 v[116:117], v204 offset:256
    ds_read_b64 v[118:119], v205 offset:256
    ds_read_b64 v[120:121], v198 offset:256
    ds_read_b64 v[122:123], v199 offset:256
    ds_read_b64 v[124:125], v206 offset:256
    ds_read_b64 v[126:127], v207 offset:256
    s_waitcnt lgkmcnt(15)
    v_dot2_f32_bf16 v60, v64, s52, v60
    v_dot2_f32_bf16 v61, v64, v64, v61
    v_dot2_f32_bf16 v62, v68, s52, v62
    v_dot2_f32_bf16 v63, v68, v68, v63
    v_dot2_f32_bf16 v60, v65, s52, v60
    v_dot2_f32_bf16 v61, v65, v65, v61
    v_dot2_f32_bf16 v62, v69, s52, v62
    v_dot2_f32_bf16 v63, v69, v69, v63
    v_dot2_f32_bf16 v60, v66, s52, v60
    v_dot2_f32_bf16 v61, v66, v66, v61
    v_dot2_f32_bf16 v62, v70, s52, v62
    v_dot2_f32_bf16 v63, v70, v70, v63
    v_dot2_f32_bf16 v60, v67, s52, v60
    v_dot2_f32_bf16 v61, v67, v67, v61
    v_dot2_f32_bf16 v62, v71, s52, v62
    v_dot2_f32_bf16 v63, v71, v71, v63
    s_waitcnt lgkmcnt(15)
    v_dot2_f32_bf16 v60, v72, s52, v60
    v_dot2_f32_bf16 v61, v72, v72, v61
    v_dot2_f32_bf16 v62, v76, s52, v62
    v_dot2_f32_bf16 v63, v76, v76, v63
    v_dot2_f32_bf16 v60, v73, s52, v60
    v_dot2_f32_bf16 v61, v73, v73, v61
    v_dot2_f32_bf16 v62, v77, s52, v62
    v_dot2_f32_bf16 v63, v77, v77, v63
    v_dot2_f32_bf16 v60, v74, s52, v60
    v_dot2_f32_bf16 v61, v74, v74, v61
    v_dot2_f32_bf16 v62, v78, s52, v62
    v_dot2_f32_bf16 v63, v78, v78, v63
    v_dot2_f32_bf16 v60, v75, s52, v60
    v_dot2_f32_bf16 v61, v75, v75, v61
    v_dot2_f32_bf16 v62, v79, s52, v62
    v_dot2_f32_bf16 v63, v79, v79, v63
    s_waitcnt lgkmcnt(15)
    v_dot2_f32_bf16 v60, v80, s52, v60
    v_dot2_f32_bf16 v61, v80, v80, v61
    v_dot2_f32_bf16 v62, v84, s52, v62
    v_dot2_f32_bf16 v63, v84, v84, v63
    v_dot2_f32_bf16 v60, v81, s52, v60
    v_dot2_f32_bf16 v61, v81, v81, v61
    v_dot2_f32_bf16 v62, v85, s52, v62
    v_dot2_f32_bf16 v63, v85, v85, v63
    v_dot2_f32_bf16 v60, v82, s52, v60
    v_dot2_f32_bf16 v61, v82, v82, v61
    v_dot2_f32_bf16 v62, v86, s52, v62
    v_dot2_f32_bf16 v63, v86, v86, v63
    v_dot2_f32_bf16 v60, v83, s52, v60
    v_dot2_f32_bf16 v61, v83, v83, v61
    v_dot2_f32_bf16 v62, v87, s52, v62
    v_dot2_f32_bf16 v63, v87, v87, v63
    s_waitcnt lgkmcnt(15)
    v_dot2_f32_bf16 v60, v88, s52, v60
    v_dot2_f32_bf16 v61, v88, v88, v61
    v_dot2_f32_bf16 v62, v92, s52, v62
    v_dot2_f32_bf16 v63, v92, v92, v63
    v_dot2_f32_bf16 v60, v89, s52, v60
    v_dot2_f32_bf16 v61, v89, v89, v61
    v_dot2_f32_bf16 v62, v93, s52, v62
    v_dot2_f32_bf16 v63, v93, v93, v63
    v_dot2_f32_bf16 v60, v90, s52, v60
    v_dot2_f32_bf16 v61, v90, v90, v61
    v_dot2_f32_bf16 v62, v94, s52, v62
    v_dot2_f32_bf16 v63, v94, v94, v63
    v_dot2_f32_bf16 v60, v91, s52, v60
    v_dot2_f32_bf16 v61, v91, v91, v61
    v_dot2_f32_bf16 v62, v95, s52, v62
    v_dot2_f32_bf16 v63, v95, v95, v63
    s_waitcnt lgkmcnt(12)
    v_dot2_f32_bf16 v60, v96, s52, v60
    v_dot2_f32_bf16 v61, v96, v96, v61
    v_dot2_f32_bf16 v62, v100, s52, v62
    v_dot2_f32_bf16 v63, v100, v100, v63
    v_dot2_f32_bf16 v60, v97, s52, v60
    v_dot2_f32_bf16 v61, v97, v97, v61
    v_dot2_f32_bf16 v62, v101, s52, v62
    v_dot2_f32_bf16 v63, v101, v101, v63
    v_dot2_f32_bf16 v60, v98, s52, v60
    v_dot2_f32_bf16 v61, v98, v98, v61
    v_dot2_f32_bf16 v62, v102, s52, v62
    v_dot2_f32_bf16 v63, v102, v102, v63
    v_dot2_f32_bf16 v60, v99, s52, v60
    v_dot2_f32_bf16 v61, v99, v99, v61
    v_dot2_f32_bf16 v62, v103, s52, v62
    v_dot2_f32_bf16 v63, v103, v103, v63
    s_waitcnt lgkmcnt(8)
    v_dot2_f32_bf16 v60, v104, s52, v60
    v_dot2_f32_bf16 v61, v104, v104, v61
    v_dot2_f32_bf16 v62, v108, s52, v62
    v_dot2_f32_bf16 v63, v108, v108, v63
    v_dot2_f32_bf16 v60, v105, s52, v60
    v_dot2_f32_bf16 v61, v105, v105, v61
    v_dot2_f32_bf16 v62, v109, s52, v62
    v_dot2_f32_bf16 v63, v109, v109, v63
    v_dot2_f32_bf16 v60, v106, s52, v60
    v_dot2_f32_bf16 v61, v106, v106, v61
    v_dot2_f32_bf16 v62, v110, s52, v62
    v_dot2_f32_bf16 v63, v110, v110, v63
    v_dot2_f32_bf16 v60, v107, s52, v60
    v_dot2_f32_bf16 v61, v107, v107, v61
    v_dot2_f32_bf16 v62, v111, s52, v62
    v_dot2_f32_bf16 v63, v111, v111, v63
    s_waitcnt lgkmcnt(4)
    v_dot2_f32_bf16 v60, v112, s52, v60
    v_dot2_f32_bf16 v61, v112, v112, v61
    v_dot2_f32_bf16 v62, v116, s52, v62
    v_dot2_f32_bf16 v63, v116, v116, v63
    v_dot2_f32_bf16 v60, v113, s52, v60
    v_dot2_f32_bf16 v61, v113, v113, v61
    v_dot2_f32_bf16 v62, v117, s52, v62
    v_dot2_f32_bf16 v63, v117, v117, v63
    v_dot2_f32_bf16 v60, v114, s52, v60
    v_dot2_f32_bf16 v61, v114, v114, v61
    v_dot2_f32_bf16 v62, v118, s52, v62
    v_dot2_f32_bf16 v63, v118, v118, v63
    v_dot2_f32_bf16 v60, v115, s52, v60
    v_dot2_f32_bf16 v61, v115, v115, v61
    v_dot2_f32_bf16 v62, v119, s52, v62
    v_dot2_f32_bf16 v63, v119, v119, v63
    s_waitcnt lgkmcnt(0)
    s_barrier
    ds_read_b64 v[36:37], v232
    ds_read_b64 v[38:39], v233
    ds_read_b64 v[40:41], v234
    ds_read_b64 v[42:43], v235
    v_dot2_f32_bf16 v60, v120, s52, v60
    v_dot2_f32_bf16 v61, v120, v120, v61
    v_dot2_f32_bf16 v62, v124, s52, v62
    v_dot2_f32_bf16 v63, v124, v124, v63
    v_dot2_f32_bf16 v60, v121, s52, v60
    v_dot2_f32_bf16 v61, v121, v121, v61
    v_dot2_f32_bf16 v62, v125, s52, v62
    v_dot2_f32_bf16 v63, v125, v125, v63
    v_dot2_f32_bf16 v60, v122, s52, v60
    v_dot2_f32_bf16 v61, v122, v122, v61
    v_dot2_f32_bf16 v62, v126, s52, v62
    v_dot2_f32_bf16 v63, v126, v126, v63
    v_dot2_f32_bf16 v60, v123, s52, v60
    v_dot2_f32_bf16 v61, v123, v123, v61
    v_dot2_f32_bf16 v62, v127, s52, v62
    v_dot2_f32_bf16 v63, v127, v127, v63
    s_nop 2
    v_permlane16_swap_b32 v60, v61
    v_permlane16_swap_b32 v62, v63
    v_add_f32 v60, v60, v61
    v_add_f32 v62, v62, v63
    v_mov_b32 v61, v60
    v_mov_b32 v63, v62
    s_nop 0
    v_permlane32_swap_b32 v60, v61
    v_permlane32_swap_b32 v62, v63
    v_add_f32 v60, v60, v61
    v_add_f32 v62, v62, v63
    v_mov_b32 v61, v60
    v_mov_b32 v63, v62
    s_nop 0
    v_permlane16_swap_b32 v60, v61
    v_permlane16_swap_b32 v62, v63
    ds_write_b128 v3, v[60:63]
    s_xor_b32 s44, s3, 1
    s_lshl_b32 s44, s44, 11
    s_add_u32 s44, s44, 154624
    v_lshl_add_u32 v4, v2, 4, s44
    s_waitcnt lgkmcnt(0)
    s_barrier
    ds_read_b128 v[192:195], v4
    s_mov_b32 s44, 0x3f80
    s_mov_b32 s45, 0x3f800000
    s_waitcnt lgkmcnt(0)
    v_add_f32 v5, v194, v60
    v_add_f32 v4, v195, v61
    v_add_f32 v8, v192, v62
    v_mul_f32 v8, 0xbb000000, v8
    v_mul_f32 v5, 0xbb000000, v5
    v_mul_f32 v4, 0x3b000000, v4
    v_fma_f32 v4, -v5, v5, v4
    v_max_f32 v4, 0, v4
    v_add_f32 v4, 0x3727c5ac, v4
    v_rsq_f32 v22, v4
    v_rsq_f32 v23, v4
    v_dot2_f32_bf16 v192, v64, s44, v5
    v_dot2_f32_bf16 v193, v64, s45, v5
    v_dot2_f32_bf16 v194, v65, s44, v5
    v_dot2_f32_bf16 v195, v65, s45, v5
    v_dot2_f32_bf16 v196, v66, s44, v5
    v_dot2_f32_bf16 v197, v66, s45, v5
    v_dot2_f32_bf16 v198, v67, s44, v5
    v_dot2_f32_bf16 v199, v67, s45, v5
    v_dot2_f32_bf16 v200, v68, s44, v8
    v_dot2_f32_bf16 v201, v68, s45, v8
    v_dot2_f32_bf16 v202, v69, s44, v8
    v_dot2_f32_bf16 v203, v69, s45, v8
    v_dot2_f32_bf16 v204, v70, s44, v8
    v_dot2_f32_bf16 v205, v70, s45, v8
    v_dot2_f32_bf16 v206, v71, s44, v8
    v_dot2_f32_bf16 v207, v71, s45, v8
    s_nop 0
    v_cvt_pk_bf16_f32 v64, v192, v193
    v_cvt_pk_bf16_f32 v65, v194, v195
    v_cvt_pk_bf16_f32 v66, v196, v197
    v_cvt_pk_bf16_f32 v67, v198, v199
    v_cvt_pk_bf16_f32 v68, v200, v201
    v_cvt_pk_bf16_f32 v69, v202, v203
    v_cvt_pk_bf16_f32 v70, v204, v205
    v_cvt_pk_bf16_f32 v71, v206, v207
    v_dot2_f32_bf16 v192, v72, s44, v5
    v_dot2_f32_bf16 v193, v72, s45, v5
    v_dot2_f32_bf16 v194, v73, s44, v5
    v_dot2_f32_bf16 v195, v73, s45, v5
    v_dot2_f32_bf16 v196, v74, s44, v5
    v_dot2_f32_bf16 v197, v74, s45, v5
    v_dot2_f32_bf16 v198, v75, s44, v5
    v_dot2_f32_bf16 v199, v75, s45, v5
    v_dot2_f32_bf16 v200, v76, s44, v8
    v_dot2_f32_bf16 v201, v76, s45, v8
    v_dot2_f32_bf16 v202, v77, s44, v8
    v_dot2_f32_bf16 v203, v77, s45, v8
    v_dot2_f32_bf16 v204, v78, s44, v8
    v_dot2_f32_bf16 v205, v78, s45, v8
    v_dot2_f32_bf16 v206, v79, s44, v8
    v_dot2_f32_bf16 v207, v79, s45, v8
    s_nop 0
    v_cvt_pk_bf16_f32 v72, v192, v193
    v_cvt_pk_bf16_f32 v73, v194, v195
    v_cvt_pk_bf16_f32 v74, v196, v197
    v_cvt_pk_bf16_f32 v75, v198, v199
    v_cvt_pk_bf16_f32 v76, v200, v201
    v_cvt_pk_bf16_f32 v77, v202, v203
    v_cvt_pk_bf16_f32 v78, v204, v205
    v_cvt_pk_bf16_f32 v79, v206, v207
    v_dot2_f32_bf16 v192, v80, s44, v5
    v_dot2_f32_bf16 v193, v80, s45, v5
    v_dot2_f32_bf16 v194, v81, s44, v5
    v_dot2_f32_bf16 v195, v81, s45, v5
    v_dot2_f32_bf16 v196, v82, s44, v5
    v_dot2_f32_bf16 v197, v82, s45, v5
    v_dot2_f32_bf16 v198, v83, s44, v5
    v_dot2_f32_bf16 v199, v83, s45, v5
    v_dot2_f32_bf16 v200, v84, s44, v8
    v_dot2_f32_bf16 v201, v84, s45, v8
    v_dot2_f32_bf16 v202, v85, s44, v8
    v_dot2_f32_bf16 v203, v85, s45, v8
    v_dot2_f32_bf16 v204, v86, s44, v8
    v_dot2_f32_bf16 v205, v86, s45, v8
    v_dot2_f32_bf16 v206, v87, s44, v8
    v_dot2_f32_bf16 v207, v87, s45, v8
    s_nop 0
    v_cvt_pk_bf16_f32 v80, v192, v193
    v_cvt_pk_bf16_f32 v81, v194, v195
    v_cvt_pk_bf16_f32 v82, v196, v197
    v_cvt_pk_bf16_f32 v83, v198, v199
    v_cvt_pk_bf16_f32 v84, v200, v201
    v_cvt_pk_bf16_f32 v85, v202, v203
    v_cvt_pk_bf16_f32 v86, v204, v205
    v_cvt_pk_bf16_f32 v87, v206, v207
    v_dot2_f32_bf16 v192, v88, s44, v5
    v_dot2_f32_bf16 v193, v88, s45, v5
    v_dot2_f32_bf16 v194, v89, s44, v5
    v_dot2_f32_bf16 v195, v89, s45, v5
    v_dot2_f32_bf16 v196, v90, s44, v5
    v_dot2_f32_bf16 v197, v90, s45, v5
    v_dot2_f32_bf16 v198, v91, s44, v5
    v_dot2_f32_bf16 v199, v91, s45, v5
    v_dot2_f32_bf16 v200, v92, s44, v8
    v_dot2_f32_bf16 v201, v92, s45, v8
    v_dot2_f32_bf16 v202, v93, s44, v8
    v_dot2_f32_bf16 v203, v93, s45, v8
    v_dot2_f32_bf16 v204, v94, s44, v8
    v_dot2_f32_bf16 v205, v94, s45, v8
    v_dot2_f32_bf16 v206, v95, s44, v8
    v_dot2_f32_bf16 v207, v95, s45, v8
    s_nop 0
    v_cvt_pk_bf16_f32 v88, v192, v193
    v_cvt_pk_bf16_f32 v89, v194, v195
    v_cvt_pk_bf16_f32 v90, v196, v197
    v_cvt_pk_bf16_f32 v91, v198, v199
    v_cvt_pk_bf16_f32 v92, v200, v201
    v_cvt_pk_bf16_f32 v93, v202, v203
    v_cvt_pk_bf16_f32 v94, v204, v205
    v_cvt_pk_bf16_f32 v95, v206, v207
    v_dot2_f32_bf16 v192, v96, s44, v5
    v_dot2_f32_bf16 v193, v96, s45, v5
    v_dot2_f32_bf16 v194, v97, s44, v5
    v_dot2_f32_bf16 v195, v97, s45, v5
    v_dot2_f32_bf16 v196, v98, s44, v5
    v_dot2_f32_bf16 v197, v98, s45, v5
    v_dot2_f32_bf16 v198, v99, s44, v5
    v_dot2_f32_bf16 v199, v99, s45, v5
    v_dot2_f32_bf16 v200, v100, s44, v8
    v_dot2_f32_bf16 v201, v100, s45, v8
    v_dot2_f32_bf16 v202, v101, s44, v8
    v_dot2_f32_bf16 v203, v101, s45, v8
    v_dot2_f32_bf16 v204, v102, s44, v8
    v_dot2_f32_bf16 v205, v102, s45, v8
    v_dot2_f32_bf16 v206, v103, s44, v8
    v_dot2_f32_bf16 v207, v103, s45, v8
    s_nop 0
    v_cvt_pk_bf16_f32 v96, v192, v193
    v_cvt_pk_bf16_f32 v97, v194, v195
    v_cvt_pk_bf16_f32 v98, v196, v197
    v_cvt_pk_bf16_f32 v99, v198, v199
    v_cvt_pk_bf16_f32 v100, v200, v201
    v_cvt_pk_bf16_f32 v101, v202, v203
    v_cvt_pk_bf16_f32 v102, v204, v205
    v_cvt_pk_bf16_f32 v103, v206, v207
    v_dot2_f32_bf16 v192, v104, s44, v5
    v_dot2_f32_bf16 v193, v104, s45, v5
    v_dot2_f32_bf16 v194, v105, s44, v5
    v_dot2_f32_bf16 v195, v105, s45, v5
    v_dot2_f32_bf16 v196, v106, s44, v5
    v_dot2_f32_bf16 v197, v106, s45, v5
    v_dot2_f32_bf16 v198, v107, s44, v5
    v_dot2_f32_bf16 v199, v107, s45, v5
    v_dot2_f32_bf16 v200, v108, s44, v8
    v_dot2_f32_bf16 v201, v108, s45, v8
    v_dot2_f32_bf16 v202, v109, s44, v8
    v_dot2_f32_bf16 v203, v109, s45, v8
    v_dot2_f32_bf16 v204, v110, s44, v8
    v_dot2_f32_bf16 v205, v110, s45, v8
    v_dot2_f32_bf16 v206, v111, s44, v8
    v_dot2_f32_bf16 v207, v111, s45, v8
    s_nop 0
    v_cvt_pk_bf16_f32 v104, v192, v193
    v_cvt_pk_bf16_f32 v105, v194, v195
    v_cvt_pk_bf16_f32 v106, v196, v197
    v_cvt_pk_bf16_f32 v107, v198, v199
    v_cvt_pk_bf16_f32 v108, v200, v201
    v_cvt_pk_bf16_f32 v109, v202, v203
    v_cvt_pk_bf16_f32 v110, v204, v205
    v_cvt_pk_bf16_f32 v111, v206, v207
    v_dot2_f32_bf16 v192, v112, s44, v5
    v_dot2_f32_bf16 v193, v112, s45, v5
    v_dot2_f32_bf16 v194, v113, s44, v5
    v_dot2_f32_bf16 v195, v113, s45, v5
    v_dot2_f32_bf16 v196, v114, s44, v5
    v_dot2_f32_bf16 v197, v114, s45, v5
    v_dot2_f32_bf16 v198, v115, s44, v5
    v_dot2_f32_bf16 v199, v115, s45, v5
    v_dot2_f32_bf16 v200, v116, s44, v8
    v_dot2_f32_bf16 v201, v116, s45, v8
    v_dot2_f32_bf16 v202, v117, s44, v8
    v_dot2_f32_bf16 v203, v117, s45, v8
    v_dot2_f32_bf16 v204, v118, s44, v8
    v_dot2_f32_bf16 v205, v118, s45, v8
    v_dot2_f32_bf16 v206, v119, s44, v8
    v_dot2_f32_bf16 v207, v119, s45, v8
    s_nop 0
    v_cvt_pk_bf16_f32 v112, v192, v193
    v_cvt_pk_bf16_f32 v113, v194, v195
    v_cvt_pk_bf16_f32 v114, v196, v197
    v_cvt_pk_bf16_f32 v115, v198, v199
    v_cvt_pk_bf16_f32 v116, v200, v201
    v_cvt_pk_bf16_f32 v117, v202, v203
    v_cvt_pk_bf16_f32 v118, v204, v205
    v_cvt_pk_bf16_f32 v119, v206, v207
    ds_read_b64_tr_b16 v[128:129], v16 offset:0
    ds_read_b64_tr_b16 v[130:131], v16 offset:2048
    ds_read_b64_tr_b16 v[132:133], v17 offset:0
    ds_read_b64_tr_b16 v[134:135], v17 offset:2048
    ds_read_b64_tr_b16 v[136:137], v18 offset:0
    ds_read_b64_tr_b16 v[138:139], v18 offset:2048
    ds_read_b64_tr_b16 v[140:141], v19 offset:0
    ds_read_b64_tr_b16 v[142:143], v19 offset:2048
    ds_read_b64_tr_b16 v[144:145], v16 offset:4096
    ds_read_b64_tr_b16 v[146:147], v16 offset:6144
    ds_read_b64_tr_b16 v[148:149], v17 offset:4096
    ds_read_b64_tr_b16 v[150:151], v17 offset:6144
    v_dot2_f32_bf16 v192, v120, s44, v5
    v_dot2_f32_bf16 v193, v120, s45, v5
    v_dot2_f32_bf16 v194, v121, s44, v5
    v_dot2_f32_bf16 v195, v121, s45, v5
    v_dot2_f32_bf16 v196, v122, s44, v5
    v_dot2_f32_bf16 v197, v122, s45, v5
    v_dot2_f32_bf16 v198, v123, s44, v5
    v_dot2_f32_bf16 v199, v123, s45, v5
    v_dot2_f32_bf16 v200, v124, s44, v8
    v_dot2_f32_bf16 v201, v124, s45, v8
    v_dot2_f32_bf16 v202, v125, s44, v8
    v_dot2_f32_bf16 v203, v125, s45, v8
    v_dot2_f32_bf16 v204, v126, s44, v8
    v_dot2_f32_bf16 v205, v126, s45, v8
    v_dot2_f32_bf16 v206, v127, s44, v8
    v_dot2_f32_bf16 v207, v127, s45, v8
    s_nop 0
    v_cvt_pk_bf16_f32 v120, v192, v193
    v_cvt_pk_bf16_f32 v121, v194, v195
    v_cvt_pk_bf16_f32 v122, v196, v197
    v_cvt_pk_bf16_f32 v123, v198, v199
    v_cvt_pk_bf16_f32 v124, v200, v201
    v_cvt_pk_bf16_f32 v125, v202, v203
    v_cvt_pk_bf16_f32 v126, v204, v205
    v_cvt_pk_bf16_f32 v127, v206, v207
    s_call_b64 s[48:49], L_pass64
    v_pk_mul_f32 v[192:193], v[192:193], v[22:23]
    v_pk_mul_f32 v[194:195], v[194:195], v[22:23]
    v_pk_mul_f32 v[196:197], v[196:197], v[22:23]
    v_pk_mul_f32 v[198:199], v[198:199], v[22:23]
    v_pk_mul_f32 v[200:201], v[200:201], v[22:23]
    v_pk_mul_f32 v[202:203], v[202:203], v[22:23]
    v_pk_mul_f32 v[204:205], v[204:205], v[22:23]
    v_pk_mul_f32 v[206:207], v[206:207], v[22:23]
    v_cvt_pk_bf16_f32 v232, v192, v193
    v_cvt_pk_bf16_f32 v233, v194, v195
    v_cvt_pk_bf16_f32 v234, v196, v197
    v_cvt_pk_bf16_f32 v235, v198, v199
    v_cvt_pk_bf16_f32 v236, v200, v201
    v_cvt_pk_bf16_f32 v237, v202, v203
    v_cvt_pk_bf16_f32 v238, v204, v205
    v_cvt_pk_bf16_f32 v239, v206, v207
    v_lshlrev_b32 v3, 7, v2
    v_lshl_add_u32 v3, v1, 5, v3
    s_cmp_eq_u32 s3, 3
    s_cbranch_scc0 L_k3d
    buffer_store_dwordx4 v[232:235], v10, s[8:11], s66 offen sc1
    buffer_store_dwordx4 v[236:239], v10, s[8:11], s66 offen offset:1024 sc1
    s_mov_b32 s55, 1
    s_mov_b64 vcc, -1
L_k3d:
    s_cselect_b32 s45, 16, 1
    s_barrier
    s_mul_i32 s44, s3, 1792
    s_add_u32 s44, s44, 148992
    v_cmp_lt_u32 s[68:69], s45, v2
    v_add_u32 v3, s44, v3
    v_mov_b32 v4, 196608
    v_cndmask_b32 v52, v4, v3, s[68:69]
    v_bfe_u32 v3, v2, 1, 2
    v_lshlrev_b32 v3, 1, v3
    v_lshrrev_b32 v4, 1, v1
    v_xor_b32 v3, v3, v4
    v_lshlrev_b32 v3, 4, v3
    v_lshl_add_u32 v3, v2, 7, v3
    v_and_b32 v4, 1, v1
    v_lshl_add_u32 v44, v4, 3, v3
    v_xor_b32 v45, 32, v44
    v_xor_b32 v46, 64, v44
    v_xor_b32 v47, 96, v44
    s_lshl_b32 s44, s3, 11
    s_add_u32 s44, s44, 154624
    v_add_u32 v48, s44, v44
    v_add_u32 v49, s44, v45
    v_add_u32 v50, s44, v46
    v_add_u32 v51, s44, v47
    s_call_b64 s[48:49], L_pass64
    v_pk_mul_f32 v[192:193], v[192:193], v[22:23]
    v_pk_mul_f32 v[194:195], v[194:195], v[22:23]
    v_pk_mul_f32 v[196:197], v[196:197], v[22:23]
    v_pk_mul_f32 v[198:199], v[198:199], v[22:23]
    v_pk_mul_f32 v[200:201], v[200:201], v[22:23]
    v_pk_mul_f32 v[202:203], v[202:203], v[22:23]
    v_pk_mul_f32 v[204:205], v[204:205], v[22:23]
    v_pk_mul_f32 v[206:207], v[206:207], v[22:23]
    v_cvt_pk_bf16_f32 v224, v192, v193
    v_cvt_pk_bf16_f32 v225, v194, v195
    v_cvt_pk_bf16_f32 v226, v196, v197
    v_cvt_pk_bf16_f32 v227, v198, v199
    v_cvt_pk_bf16_f32 v228, v200, v201
    v_cvt_pk_bf16_f32 v229, v202, v203
    v_cvt_pk_bf16_f32 v230, v204, v205
    v_cvt_pk_bf16_f32 v231, v206, v207
    ds_write_b64 v48, v[224:225]
    ds_write_b64 v49, v[226:227]
    ds_write_b64 v50, v[228:229]
    ds_write_b64 v51, v[230:231]
    ds_write_b128 v52, v[232:235]
    ds_write_b128 v52, v[236:239] offset:16
    s_cmp_eq_u32 s3, 3
    s_cbranch_scc0 L_v3d
    buffer_store_dwordx4 v[224:227], v10, s[8:11], s66 offen offset:2048 sc1
    buffer_store_dwordx4 v[228:231], v10, s[8:11], s66 offen offset:3072 sc1
    s_mov_b32 s55, 0x100
    s_mov_b64 vcc, -1
L_v3d:
    v_max_u32 v3, 2, v2
    v_lshlrev_b32 v3, 7, v3
    v_lshl_add_u32 v3, v1, 5, v3
    s_mul_i32 s45, s3, 1792
    s_add_u32 s45, s45, 147200
    v_add_u32 v3, s45, v3
    s_sub_u32 s45, s44, 2048
    s_cmp_eq_u32 s3, 0
    s_cselect_b32 s45, 131072, s45
    s_cselect_b32 s47, 1, 0
    v_add_u32 v44, s44, v12
    v_add_u32 v48, s45, v12
    v_add_u32 v45, s44, v13
    v_add_u32 v49, s45, v13
    v_add_u32 v46, s44, v14
    v_add_u32 v50, s45, v14
    v_add_u32 v47, s44, v15
    v_add_u32 v51, s45, v15
    s_waitcnt lgkmcnt(0)
    s_barrier
    s_call_b64 s[48:49], L_pass64
    ds_write_b32 v248, v250 offset:32
    ds_read_b64_tr_b16 v[80:81], v44
    ds_read_b64_tr_b16 v[82:83], v45
    ds_read_b64_tr_b16 v[84:85], v46
    ds_read_b64_tr_b16 v[86:87], v47
    v_pk_mul_f32 v[192:193], v[192:193], v[22:23]
    v_pk_mul_f32 v[194:195], v[194:195], v[22:23]
    v_pk_mul_f32 v[196:197], v[196:197], v[22:23]
    v_pk_mul_f32 v[198:199], v[198:199], v[22:23]
    v_pk_mul_f32 v[200:201], v[200:201], v[22:23]
    v_pk_mul_f32 v[202:203], v[202:203], v[22:23]
    v_pk_mul_f32 v[204:205], v[204:205], v[22:23]
    v_pk_mul_f32 v[206:207], v[206:207], v[22:23]
    v_cvt_pk_bf16_f32 v224, v192, v193
    v_cvt_pk_bf16_f32 v225, v194, v195
    v_cvt_pk_bf16_f32 v226, v196, v197
    v_cvt_pk_bf16_f32 v227, v198, v199
    v_cvt_pk_bf16_f32 v228, v200, v201
    v_cvt_pk_bf16_f32 v229, v202, v203
    v_cvt_pk_bf16_f32 v230, v204, v205
    v_cvt_pk_bf16_f32 v231, v206, v207
L_kv_1:
    ds_read_b32 v9, v7 offset:0
    ds_read_b128 v[64:67], v3
    ds_read_b128 v[68:71], v3 offset:16
    v_mfma_f32_16x16x16_bf16 v[88:91], v[232:233], v[224:225], 0
    v_mfma_f32_16x16x16_bf16 v[92:95], v[234:235], v[226:227], 0
    v_mfma_f32_16x16x16_bf16 v[96:99], v[236:237], v[228:229], 0
    v_mfma_f32_16x16x16_bf16 v[100:103], v[238:239], v[230:231], 0
    s_waitcnt lgkmcnt(0)
    v_readfirstlane_b32 s46, v9
    s_cmp_ge_u32 s46, s47
    s_cbranch_scc0 L_kv_1_s
L_kv_1_d:
    v_mfma_f32_16x16x16_bf16 v[104:107], v[64:65], v[224:225], 0
    v_mfma_f32_16x16x16_bf16 v[108:111], v[66:67], v[226:227], 0
    v_mfma_f32_16x16x16_bf16 v[112:115], v[68:69], v[228:229], 0
    v_mfma_f32_16x16x16_bf16 v[116:119], v[70:71], v[230:231], 0
    s_nop 3
    v_cndmask_b32 v192, v88, v89, s[58:59]
    v_cndmask_b32 v193, v90, v91, s[58:59]
    v_cndmask_b32 v196, v92, v93, s[58:59]
    v_cndmask_b32 v197, v94, v95, s[58:59]
    v_cndmask_b32 v200, v96, v97, s[58:59]
    v_cndmask_b32 v201, v98, v99, s[58:59]
    v_cndmask_b32 v204, v100, v101, s[58:59]
    v_cndmask_b32 v205, v102, v103, s[58:59]
    v_cndmask_b32 v194, v104, v105, s[58:59]
    v_cndmask_b32 v195, v106, v107, s[58:59]
    v_cndmask_b32 v198, v108, v109, s[58:59]
    v_cndmask_b32 v199, v110, v111, s[58:59]
    v_cndmask_b32 v202, v112, v113, s[58:59]
    v_cndmask_b32 v203, v114, v115, s[58:59]
    v_cndmask_b32 v206, v116, v117, s[58:59]
    v_cndmask_b32 v207, v118, v119, s[58:59]
    v_fma_f32 v192, v192, s53, v54
    v_fma_f32 v193, v193, s53, v55
    v_fma_f32 v194, v194, s53, v56
    v_fma_f32 v195, v195, s53, v57
    v_fma_f32 v196, v196, s53, v54
    v_fma_f32 v197, v197, s53, v55
    v_fma_f32 v198, v198, s53, v56
    v_fma_f32 v199, v199, s53, v57
    v_fma_f32 v200, v200, s53, v54
    v_fma_f32 v201, v201, s53, v55
    v_fma_f32 v202, v202, s53, v56
    v_fma_f32 v203, v203, s53, v57
    v_fma_f32 v204, v204, s53, v54
    v_fma_f32 v205, v205, s53, v55
    v_fma_f32 v206, v206, s53, v56
    v_fma_f32 v207, v207, s53, v57
    v_max3_f32 v208, v192, v193, v194
    v_max3_f32 v209, v196, v197, v198
    v_max3_f32 v210, v200, v201, v202
    v_max3_f32 v211, v204, v205, v206
    v_max_f32 v208, v208, v195
    v_max_f32 v209, v209, v199
    v_max_f32 v210, v210, v203
    v_max_f32 v211, v211, v207
    v_mov_b32 v212, v208
    v_mov_b32 v213, v209
    v_mov_b32 v214, v210
    v_mov_b32 v215, v211
    s_nop 0
    v_permlane16_swap_b32 v208, v212
    v_permlane16_swap_b32 v209, v213
    v_permlane16_swap_b32 v210, v214
    v_permlane16_swap_b32 v211, v215
    v_max_f32 v208, v208, v212
    v_max_f32 v209, v209, v213
    v_max_f32 v210, v210, v214
    v_max_f32 v211, v211, v215
    v_mov_b32 v212, v208
    v_mov_b32 v213, v209
    v_mov_b32 v214, v210
    v_mov_b32 v215, v211
    s_nop 0
    v_permlane32_swap_b32 v208, v212
    v_permlane32_swap_b32 v209, v213
    v_permlane32_swap_b32 v210, v214
    v_permlane32_swap_b32 v211, v215
    v_max_f32 v208, v208, v212
    v_max_f32 v209, v209, v213
    v_max_f32 v210, v210, v214
    v_max_f32 v211, v211, v215
    v_sub_f32 v192, v192, v208
    v_sub_f32 v193, v193, v208
    v_sub_f32 v194, v194, v208
    v_sub_f32 v195, v195, v208
    v_sub_f32 v196, v196, v209
    v_sub_f32 v197, v197, v209
    v_sub_f32 v198, v198, v209
    v_sub_f32 v199, v199, v209
    v_sub_f32 v200, v200, v210
    v_sub_f32 v201, v201, v210
    v_sub_f32 v202, v202, v210
    v_sub_f32 v203, v203, v210
    v_sub_f32 v204, v204, v211
    v_sub_f32 v205, v205, v211
    v_sub_f32 v206, v206, v211
    v_sub_f32 v207, v207, v211
    v_exp_f32 v192, v192
    v_exp_f32 v193, v193
    v_exp_f32 v194, v194
    v_exp_f32 v195, v195
    v_exp_f32 v196, v196
    v_exp_f32 v197, v197
    v_exp_f32 v198, v198
    v_exp_f32 v199, v199
    v_exp_f32 v200, v200
    v_exp_f32 v201, v201
    v_exp_f32 v202, v202
    v_exp_f32 v203, v203
    v_exp_f32 v204, v204
    v_exp_f32 v205, v205
    v_exp_f32 v206, v206
    v_exp_f32 v207, v207
    v_add_f32 v208, v192, v193
    v_add_f32 v209, v196, v197
    v_add_f32 v210, v200, v201
    v_add_f32 v211, v204, v205
    v_add_f32 v212, v194, v195
    v_add_f32 v213, v198, v199
    v_add_f32 v214, v202, v203
    v_add_f32 v215, v206, v207
    v_add_f32 v208, v208, v212
    v_add_f32 v209, v209, v213
    v_add_f32 v210, v210, v214
    v_add_f32 v211, v211, v215
    v_mov_b32 v212, v208
    v_mov_b32 v213, v209
    v_mov_b32 v214, v210
    v_mov_b32 v215, v211
    s_nop 0
    v_permlane16_swap_b32 v208, v212
    v_permlane16_swap_b32 v209, v213
    v_permlane16_swap_b32 v210, v214
    v_permlane16_swap_b32 v211, v215
    v_add_f32 v208, v208, v212
    v_add_f32 v209, v209, v213
    v_add_f32 v210, v210, v214
    v_add_f32 v211, v211, v215
    v_mov_b32 v212, v208
    v_mov_b32 v213, v209
    v_mov_b32 v214, v210
    v_mov_b32 v215, v211
    s_nop 0
    v_permlane32_swap_b32 v208, v212
    v_permlane32_swap_b32 v209, v213
    v_permlane32_swap_b32 v210, v214
    v_permlane32_swap_b32 v211, v215
    v_add_f32 v208, v208, v212
    v_add_f32 v209, v209, v213
    v_add_f32 v210, v210, v214
    v_add_f32 v211, v211, v215
    v_rcp_f32 v208, v208
    v_rcp_f32 v209, v209
    v_rcp_f32 v210, v210
    v_rcp_f32 v211, v211
    s_lshl_b32 s47, s47, 1
L_vv_2:
    ds_read_b32 v9, v7 offset:0
    ds_read_b64_tr_b16 v[72:73], v48
    ds_read_b64_tr_b16 v[74:75], v49
    ds_read_b64_tr_b16 v[76:77], v50
    ds_read_b64_tr_b16 v[78:79], v51
    s_cbranch_vccnz L_vv_2_w
    v_mul_f32 v192, v192, v208
    v_mul_f32 v193, v193, v208
    v_mul_f32 v194, v194, v208
    v_mul_f32 v195, v195, v208
    v_mul_f32 v196, v196, v209
    v_mul_f32 v197, v197, v209
    v_mul_f32 v198, v198, v209
    v_mul_f32 v199, v199, v209
    v_mul_f32 v200, v200, v210
    v_mul_f32 v201, v201, v210
    v_mul_f32 v202, v202, v210
    v_mul_f32 v203, v203, v210
    v_mul_f32 v204, v204, v211
    v_mul_f32 v205, v205, v211
    v_mul_f32 v206, v206, v211
    v_mul_f32 v207, v207, v211
    v_cvt_pk_bf16_f32 v208, v192, v193
    v_cvt_pk_bf16_f32 v212, v194, v195
    v_cvt_pk_bf16_f32 v209, v196, v197
    v_cvt_pk_bf16_f32 v213, v198, v199
    v_cvt_pk_bf16_f32 v210, v200, v201
    v_cvt_pk_bf16_f32 v214, v202, v203
    v_cvt_pk_bf16_f32 v211, v204, v205
    v_cvt_pk_bf16_f32 v215, v206, v207
    v_perm_b32 v88, v208, v208, v58
    v_perm_b32 v89, v208, v208, v59
    v_perm_b32 v104, v212, v212, v58
    v_perm_b32 v105, v212, v212, v59
    v_perm_b32 v90, v209, v209, v58
    v_perm_b32 v91, v209, v209, v59
    v_perm_b32 v106, v213, v213, v58
    v_perm_b32 v107, v213, v213, v59
    v_perm_b32 v92, v210, v210, v58
    v_perm_b32 v93, v210, v210, v59
    v_perm_b32 v108, v214, v214, v58
    v_perm_b32 v109, v214, v214, v59
    v_perm_b32 v94, v211, v211, v58
    v_perm_b32 v95, v211, v211, v59
    v_perm_b32 v110, v215, v215, v58
    v_perm_b32 v111, v215, v215, v59
    s_nop 1
    v_mfma_f32_16x16x16_bf16 v[192:195], v[80:81], v[88:89], 0
    v_mfma_f32_16x16x16_bf16 v[196:199], v[82:83], v[90:91], 0
    v_mfma_f32_16x16x16_bf16 v[200:203], v[84:85], v[92:93], 0
    v_mfma_f32_16x16x16_bf16 v[204:207], v[86:87], v[94:95], 0
L_vv_2_w:
    s_waitcnt lgkmcnt(0)
    v_readfirstlane_b32 s46, v9
    s_mov_b64 vcc, -1
    s_cmp_ge_u32 s46, s47
    s_cbranch_scc0 L_vv_2_s
L_vv_2_d:
    s_mov_b64 vcc, 0
    v_mfma_f32_16x16x16_bf16 v[192:195], v[72:73], v[104:105], v[192:195]
    v_mfma_f32_16x16x16_bf16 v[196:199], v[74:75], v[106:107], v[196:199]
    v_mfma_f32_16x16x16_bf16 v[200:203], v[76:77], v[108:109], v[200:203]
    v_mfma_f32_16x16x16_bf16 v[204:207], v[78:79], v[110:111], v[204:207]
    s_nop 1
    s_nop 2
    v_cvt_pk_bf16_f32 v224, v192, v193
    v_cvt_pk_bf16_f32 v225, v194, v195
    v_cvt_pk_bf16_f32 v226, v196, v197
    v_cvt_pk_bf16_f32 v227, v198, v199
    v_cvt_pk_bf16_f32 v228, v200, v201
    v_cvt_pk_bf16_f32 v229, v202, v203
    v_cvt_pk_bf16_f32 v230, v204, v205
    v_cvt_pk_bf16_f32 v231, v206, v207
    s_add_u32 s44, s62, 0
    buffer_store_dwordx4 v[224:227], v10, s[8:11], s44 offen sc1
    buffer_store_dwordx4 v[228:231], v10, s[8:11], s44 offen offset:1024 sc1
    v_mov_b32 v176, 0
    v_mov_b32 v177, 0
    v_mov_b32 v178, 0
    v_mov_b32 v179, 0
    v_mov_b32 v180, 0
    v_mov_b32 v181, 0
    v_mov_b32 v182, 0
    v_mov_b32 v183, 0
    v_mov_b32 v184, 0
    v_mov_b32 v185, 0
    v_mov_b32 v186, 0
    v_mov_b32 v187, 0
    v_mov_b32 v188, 0
    v_mov_b32 v189, 0
    v_mov_b32 v190, 0
    v_mov_b32 v191, 0
    s_lshl_b32 s60, s40, 15
    s_add_u32 s60, s60, 0
    s_add_u32 s57, s63, 0
    s_mov_b32 s89, 1
    v_lshlrev_b32 v160, 16, v36
    v_and_b32 v161, 0xffff0000, v36
    v_lshlrev_b32 v162, 16, v37
    v_and_b32 v163, 0xffff0000, v37
    v_lshlrev_b32 v164, 16, v38
    v_and_b32 v165, 0xffff0000, v38
    v_lshlrev_b32 v166, 16, v39
    v_and_b32 v167, 0xffff0000, v39
    v_lshlrev_b32 v168, 16, v40
    v_and_b32 v169, 0xffff0000, v40
    v_lshlrev_b32 v170, 16, v41
    v_and_b32 v171, 0xffff0000, v41
    v_lshlrev_b32 v172, 16, v42
    v_and_b32 v173, 0xffff0000, v42
    v_lshlrev_b32 v174, 16, v43
    v_and_b32 v175, 0xffff0000, v43
    s_waitcnt vmcnt(0)
    buffer_atomic_add v250, v11, s[8:11], s63 offen offset:0 sc1
    s_barrier
    ds_read_b64_tr_b16 v[128:129], v16 offset:0
    ds_read_b64_tr_b16 v[130:131], v16 offset:2048
    ds_read_b64_tr_b16 v[132:133], v17 offset:0
    ds_read_b64_tr_b16 v[134:135], v17 offset:2048
    ds_read_b64_tr_b16 v[136:137], v18 offset:0
    ds_read_b64_tr_b16 v[138:139], v18 offset:2048
    ds_read_b64_tr_b16 v[140:141], v19 offset:0
    ds_read_b64_tr_b16 v[142:143], v19 offset:2048
    ds_read_b64_tr_b16 v[144:145], v16 offset:4096
    ds_read_b64_tr_b16 v[146:147], v16 offset:6144
    ds_read_b64_tr_b16 v[148:149], v17 offset:4096
    ds_read_b64_tr_b16 v[150:151], v17 offset:6144
    s_mov_b32 s44, 91
L_rdy_3:
    s_mov_b32 s56, 0
    s_atomic_add s56, s[36:37], s57 glc
    s_waitcnt lgkmcnt(0)
L_rdy_3_c:
    s_andn2_b32 s46, s44, s56
    s_cbranch_scc1 L_rdy_3_s
L_rdy_3_d:
    buffer_load_dwordx4 v[64:67], v32, s[8:11], s60 offen offset:0 sc1
    buffer_load_dwordx4 v[68:71], v33, s[8:11], s60 offen offset:0 sc1
    buffer_load_dwordx4 v[72:75], v32, s[8:11], s60 offen offset:1024 sc1
    buffer_load_dwordx4 v[76:79], v33, s[8:11], s60 offen offset:1024 sc1
    buffer_load_dwordx4 v[80:83], v32, s[8:11], s60 offen offset:2048 sc1
    buffer_load_dwordx4 v[84:87], v33, s[8:11], s60 offen offset:2048 sc1
    buffer_load_dwordx4 v[88:91], v32, s[8:11], s60 offen offset:3072 sc1
    buffer_load_dwordx4 v[92:95], v33, s[8:11], s60 offen offset:3072 sc1
    s_mov_b32 s44, 23296
    s_branch L_rdy_4_c
L_rdy_4:
    s_mov_b32 s56, 0
    s_atomic_add s56, s[36:37], s57 glc
    s_waitcnt lgkmcnt(0)
L_rdy_4_c:
    s_andn2_b32 s46, s44, s56
    s_cbranch_scc1 L_rdy_4_s
L_rdy_4_d:
    buffer_load_dwordx4 v[96:99], v34, s[8:11], s60 offen offset:0 sc1
    buffer_load_dwordx4 v[100:103], v35, s[8:11], s60 offen offset:0 sc1
    buffer_load_dwordx4 v[104:107], v34, s[8:11], s60 offen offset:1024 sc1
    buffer_load_dwordx4 v[108:111], v35, s[8:11], s60 offen offset:1024 sc1
    buffer_load_dwordx4 v[112:115], v34, s[8:11], s60 offen offset:2048 sc1
    buffer_load_dwordx4 v[116:119], v35, s[8:11], s60 offen offset:2048 sc1
    buffer_load_dwordx4 v[120:123], v34, s[8:11], s60 offen offset:3072 sc1
    buffer_load_dwordx4 v[124:127], v35, s[8:11], s60 offen offset:3072 sc1
    s_call_b64 s[48:49], L_pass64b
    v_cvt_pk_bf16_f32 v44, v192, v193
    v_cvt_pk_bf16_f32 v45, v194, v195
    v_cvt_pk_bf16_f32 v46, v196, v197
    v_cvt_pk_bf16_f32 v47, v198, v199
    v_cvt_pk_bf16_f32 v48, v200, v201
    v_cvt_pk_bf16_f32 v49, v202, v203
    v_cvt_pk_bf16_f32 v50, v204, v205
    v_cvt_pk_bf16_f32 v51, v206, v207
    s_add_u32 s44, s62, 2097152
    buffer_store_dwordx4 v[44:47], v10, s[8:11], s44 offen sc1
    buffer_store_dwordx4 v[48:51], v10, s[8:11], s44 offen offset:1024 sc1
    v_mov_b32 v60, 0
    v_mov_b32 v61, 0
    v_dot2_f32_bf16 v60, v44, s52, v60
    v_dot2_f32_bf16 v61, v44, v44, v61
    v_dot2_f32_bf16 v60, v45, s52, v60
    v_dot2_f32_bf16 v61, v45, v45, v61
    v_dot2_f32_bf16 v60, v46, s52, v60
    v_dot2_f32_bf16 v61, v46, v46, v61
    v_dot2_f32_bf16 v60, v47, s52, v60
    v_dot2_f32_bf16 v61, v47, v47, v61
    v_dot2_f32_bf16 v60, v48, s52, v60
    v_dot2_f32_bf16 v61, v48, v48, v61
    v_dot2_f32_bf16 v60, v49, s52, v60
    v_dot2_f32_bf16 v61, v49, v49, v61
    v_dot2_f32_bf16 v60, v50, s52, v60
    v_dot2_f32_bf16 v61, v50, v50, v61
    v_dot2_f32_bf16 v60, v51, s52, v60
    v_dot2_f32_bf16 v61, v51, v51, v61
    s_mov_b32 s44, 15728640
    s_nop 1
    v_permlane16_swap_b32 v60, v61
    v_add_f32 v60, v60, v61
    v_mov_b32 v61, v60
    s_nop 1
    v_permlane32_swap_b32 v60, v61
    v_add_f32 v60, v60, v61
    v_mov_b32 v61, v60
    s_nop 1
    v_permlane16_swap_b32 v60, v61
    buffer_store_dwordx2 v[60:61], v26, s[8:11], s44 offen sc1
    s_lshl_b32 s60, s40, 15
    s_add_u32 s60, s60, 2097152
    s_lshl_b32 s47, s41, 10
    s_add_u32 s47, s47, 15728640
    s_waitcnt vmcnt(0)
    buffer_atomic_add v251, v11, s[8:11], s63 offen offset:0 sc1
    s_barrier
    ds_read_b64_tr_b16 v[128:129], v16 offset:0
    ds_read_b64_tr_b16 v[130:131], v16 offset:2048
    ds_read_b64_tr_b16 v[132:133], v17 offset:0
    ds_read_b64_tr_b16 v[134:135], v17 offset:2048
    ds_read_b64_tr_b16 v[136:137], v18 offset:0
    ds_read_b64_tr_b16 v[138:139], v18 offset:2048
    ds_read_b64_tr_b16 v[140:141], v19 offset:0
    ds_read_b64_tr_b16 v[142:143], v19 offset:2048
    ds_read_b64_tr_b16 v[144:145], v16 offset:4096
    ds_read_b64_tr_b16 v[146:147], v16 offset:6144
    ds_read_b64_tr_b16 v[148:149], v17 offset:4096
    ds_read_b64_tr_b16 v[150:151], v17 offset:6144
    s_mov_b32 s44, 5963776
L_rdy_5:
    s_mov_b32 s56, 0
    s_atomic_add s56, s[36:37], s57 glc
    s_waitcnt lgkmcnt(0)
L_rdy_5_c:
    s_andn2_b32 s46, s44, s56
    s_cbranch_scc1 L_rdy_5_s
L_rdy_5_d:
    buffer_load_dwordx4 v[64:67], v32, s[8:11], s60 offen offset:0 sc1
    buffer_load_dwordx4 v[68:71], v33, s[8:11], s60 offen offset:0 sc1
    buffer_load_dwordx4 v[72:75], v32, s[8:11], s60 offen offset:1024 sc1
    buffer_load_dwordx4 v[76:79], v33, s[8:11], s60 offen offset:1024 sc1
    buffer_load_dwordx4 v[80:83], v32, s[8:11], s60 offen offset:2048 sc1
    buffer_load_dwordx4 v[84:87], v33, s[8:11], s60 offen offset:2048 sc1
    buffer_load_dwordx4 v[88:91], v32, s[8:11], s60 offen offset:3072 sc1
    buffer_load_dwordx4 v[92:95], v33, s[8:11], s60 offen offset:3072 sc1
    s_mov_b32 s44, 1526726656
    s_branch L_rdy_6_c
L_rdy_6:
    s_mov_b32 s56, 0
    s_atomic_add s56, s[36:37], s57 glc
    s_waitcnt lgkmcnt(0)
L_rdy_6_c:
    s_andn2_b32 s46, s44, s56
    s_cbranch_scc1 L_rdy_6_s
L_rdy_6_d:
    buffer_load_dwordx4 v[96:99], v34, s[8:11], s60 offen offset:0 sc1
    buffer_load_dwordx4 v[100:103], v35, s[8:11], s60 offen offset:0 sc1
    buffer_load_dwordx4 v[104:107], v34, s[8:11], s60 offen offset:1024 sc1
    buffer_load_dwordx4 v[108:111], v35, s[8:11], s60 offen offset:1024 sc1
    buffer_load_dwordx4 v[112:115], v34, s[8:11], s60 offen offset:2048 sc1
    buffer_load_dwordx4 v[116:119], v35, s[8:11], s60 offen offset:2048 sc1
    buffer_load_dwordx4 v[120:123], v34, s[8:11], s60 offen offset:3072 sc1
    buffer_load_dwordx4 v[124:127], v35, s[8:11], s60 offen offset:3072 sc1
    s_mov_b32 s44, 4294901760
    s_branch L_rdy_7_c
L_rdy_7:
    s_mov_b32 s56, 0
    s_atomic_add s56, s[36:37], s57 glc
    s_waitcnt lgkmcnt(0)
L_rdy_7_c:
    s_andn2_b32 s46, s44, s56
    s_cbranch_scc1 L_rdy_7_s
L_rdy_7_d:
    buffer_load_dwordx4 v[60:63], v10, s[8:11], s47 offen sc1
    s_mov_b32 s43, 0
    s_call_b64 s[48:49], L_pass64
    v_add_f32 v5, v60, v62
    v_add_f32 v4, v61, v63
    s_nop 1
    v_permlane16_swap_b32 v5, v4
    v_add_f32 v5, v5, v4
    v_mov_b32 v4, v5
    s_nop 1
    v_permlane32_swap_b32 v5, v4
    v_add_f32 v5, v5, v4
    v_mov_b32 v4, v5
    s_nop 1
    v_permlane16_swap_b32 v5, v4
    v_mul_f32 v5, 0xbb000000, v5
    v_mul_f32 v4, 0x3b000000, v4
    v_fma_f32 v4, -v5, v5, v4
    v_max_f32 v4, 0, v4
    v_add_f32 v3, 0x3727c5ac, v4
    v_rsq_f32 v24, v3
    v_mov_b32 v244, v5
    v_mul_f32 v4, v4, v24
    v_fmaak_f32 v4, v4, v24, 0x3727c5ac
    v_rsq_f32 v4, v4
    v_mov_b32 v245, v5
    v_mul_f32 v22, v4, v24
    v_mul_f32 v23, v4, v24
    v_mov_b32 v25, v24
    v_mul_f32 v240, v5, v22
    v_mul_f32 v241, v5, v22
L_cs_8_c:
    v_min_u32 v252, v252, v253
    s_nop 0
    v_readfirstlane_b32 s44, v252
    s_cmp_ge_u32 s44, 1
    s_cbranch_scc0 L_cs_8
L_cs_8_d:
    s_call_b64 s[50:51], L_gelu
    s_lshl_b32 s44, s38, 11
    s_add_u32 s44, s44, 4194304
    buffer_store_dwordx4 v[224:227], v254, s[8:11], s44 offen sc1
    buffer_store_dwordx4 v[228:231], v254, s[8:11], s44 offen offset:1024 sc1
    v_mov_b32 v8, 1073741824
    s_lshl_b32 s46, s67, 1
    s_sub_u32 s46, s46, 1
    s_movk_i32 s47, 0x800
    s_lshl_b32 s44, s41, 4
    s_add_u32 s44, s44, s46
    v_add_u32 v3, s44, v2
    v_cmp_gt_u32 s[68:69], s47, v3
    s_nop 1
    v_cndmask_b32 v32, v8, v32, s[68:69]
    s_xor_b32 s44, s41, 1
    s_lshl_b32 s44, s44, 4
    s_add_u32 s44, s44, s46
    v_add_u32 v3, s44, v2
    v_cmp_gt_u32 s[68:69], s47, v3
    s_nop 1
    v_cndmask_b32 v33, v8, v33, s[68:69]
    s_lshl_b32 s44, s41, 4
    s_add_u32 s44, s44, s46
    s_add_u32 s44, s44, s46
    v_add_u32 v3, s44, v2
    v_cmp_gt_u32 s[68:69], s47, v3
    s_nop 1
    v_cndmask_b32 v34, v8, v34, s[68:69]
    s_xor_b32 s44, s41, 1
    s_lshl_b32 s44, s44, 4
    s_add_u32 s44, s44, s46
    s_add_u32 s44, s44, s46
    v_add_u32 v3, s44, v2
    v_cmp_gt_u32 s[68:69], s47, v3
    s_nop 1
    v_cndmask_b32 v35, v8, v35, s[68:69]
    v_lshlrev_b32 v160, 16, v44
    v_and_b32 v161, 0xffff0000, v44
    v_lshlrev_b32 v162, 16, v45
    v_and_b32 v163, 0xffff0000, v45
    v_lshlrev_b32 v164, 16, v46
    v_and_b32 v165, 0xffff0000, v46
    v_lshlrev_b32 v166, 16, v47
    v_and_b32 v167, 0xffff0000, v47
    v_lshlrev_b32 v168, 16, v48
    v_and_b32 v169, 0xffff0000, v48
    v_lshlrev_b32 v170, 16, v49
    v_and_b32 v171, 0xffff0000, v49
    v_lshlrev_b32 v172, 16, v50
    v_and_b32 v173, 0xffff0000, v50
    v_lshlrev_b32 v174, 16, v51
    v_and_b32 v175, 0xffff0000, v51
    v_pk_add_f32 v[160:161], v[160:161], v[244:245]
    v_pk_add_f32 v[162:163], v[162:163], v[244:245]
    v_pk_add_f32 v[164:165], v[164:165], v[244:245]
    v_pk_add_f32 v[166:167], v[166:167], v[244:245]
    v_pk_add_f32 v[168:169], v[168:169], v[244:245]
    v_pk_add_f32 v[170:171], v[170:171], v[244:245]
    v_pk_add_f32 v[172:173], v[172:173], v[244:245]
    v_pk_add_f32 v[174:175], v[174:175], v[244:245]
    v_pk_mul_f32 v[160:161], v[160:161], v[24:25]
    v_pk_mul_f32 v[162:163], v[162:163], v[24:25]
    v_pk_mul_f32 v[164:165], v[164:165], v[24:25]
    v_pk_mul_f32 v[166:167], v[166:167], v[24:25]
    v_pk_mul_f32 v[168:169], v[168:169], v[24:25]
    v_pk_mul_f32 v[170:171], v[170:171], v[24:25]
    v_pk_mul_f32 v[172:173], v[172:173], v[24:25]
    v_pk_mul_f32 v[174:175], v[174:175], v[24:25]
    v_mov_b32 v176, 0
    v_mov_b32 v177, 0
    v_mov_b32 v178, 0
    v_mov_b32 v179, 0
    v_mov_b32 v180, 0
    v_mov_b32 v181, 0
    v_mov_b32 v182, 0
    v_mov_b32 v183, 0
    v_mov_b32 v184, 0
    v_mov_b32 v185, 0
    v_mov_b32 v186, 0
    v_mov_b32 v187, 0
    v_mov_b32 v188, 0
    v_mov_b32 v189, 0
    v_mov_b32 v190, 0
    v_mov_b32 v191, 0
    s_lshl_b32 s44, s46, 7
    s_add_u32 s92, s63, s44
    s_add_u32 s44, s40, s46
    s_cmp_gt_u32 s44, 63
    s_cselect_b32 s92, s63, s92
    s_add_u32 s92, s92, 4
    s_cmp_eq_u32 s67, 0
    s_cselect_b32 s93, 0x0a, 0x50
    s_add_u32 s57, s63, 4
    s_lshl_b32 s60, s40, 15
    s_add_u32 s60, s60, 4194304
    v_add_u32 v246, 256, v246
    s_waitcnt vmcnt(0)
    buffer_atomic_add v250, v11, s[8:11], s63 offen offset:4 sc1
    s_barrier
    ds_read_b64_tr_b16 v[128:129], v16 offset:0
    ds_read_b64_tr_b16 v[130:131], v16 offset:2048
    ds_read_b64_tr_b16 v[132:133], v17 offset:0
    ds_read_b64_tr_b16 v[134:135], v17 offset:2048
    ds_read_b64_tr_b16 v[136:137], v18 offset:0
    ds_read_b64_tr_b16 v[138:139], v18 offset:2048
    ds_read_b64_tr_b16 v[140:141], v19 offset:0
    ds_read_b64_tr_b16 v[142:143], v19 offset:2048
    ds_read_b64_tr_b16 v[144:145], v16 offset:4096
    ds_read_b64_tr_b16 v[146:147], v16 offset:6144
    ds_read_b64_tr_b16 v[148:149], v17 offset:4096
    ds_read_b64_tr_b16 v[150:151], v17 offset:6144
    s_mov_b32 s44, 91
    s_lshl_b32 s45, s93, 0
L_rdy_9:
    s_mov_b32 s56, 0
    s_mov_b32 s72, 0
    s_atomic_add s56, s[36:37], s57 glc
    s_atomic_add s72, s[36:37], s92 glc
    s_waitcnt lgkmcnt(0)
L_rdy_9_c:
    s_andn2_b32 s46, s44, s56
    s_andn2_b32 s73, s45, s72
    s_or_b32 s46, s46, s73
    s_cbranch_scc1 L_rdy_9_s
L_rdy_9_d:
    buffer_load_dwordx4 v[64:67], v32, s[8:11], s60 offen offset:0 sc1
    buffer_load_dwordx4 v[68:71], v33, s[8:11], s60 offen offset:0 sc1
    buffer_load_dwordx4 v[72:75], v32, s[8:11], s60 offen offset:1024 sc1
    buffer_load_dwordx4 v[76:79], v33, s[8:11], s60 offen offset:1024 sc1
    buffer_load_dwordx4 v[80:83], v32, s[8:11], s60 offen offset:2048 sc1
    buffer_load_dwordx4 v[84:87], v33, s[8:11], s60 offen offset:2048 sc1
    buffer_load_dwordx4 v[88:91], v32, s[8:11], s60 offen offset:3072 sc1
    buffer_load_dwordx4 v[92:95], v33, s[8:11], s60 offen offset:3072 sc1
    s_mov_b32 s44, 23296
    s_lshl_b32 s45, s93, 8
    s_branch L_rdy_10_c
L_rdy_10:
    s_mov_b32 s56, 0
    s_mov_b32 s72, 0
    s_atomic_add s56, s[36:37], s57 glc
    s_atomic_add s72, s[36:37], s92 glc
    s_waitcnt lgkmcnt(0)
L_rdy_10_c:
    s_andn2_b32 s46, s44, s56
    s_andn2_b32 s73, s45, s72
    s_or_b32 s46, s46, s73
    s_cbranch_scc1 L_rdy_10_s
L_rdy_10_d:
    buffer_load_dwordx4 v[96:99], v34, s[8:11], s60 offen offset:0 sc1
    buffer_load_dwordx4 v[100:103], v35, s[8:11], s60 offen offset:0 sc1
    buffer_load_dwordx4 v[104:107], v34, s[8:11], s60 offen offset:1024 sc1
    buffer_load_dwordx4 v[108:111], v35, s[8:11], s60 offen offset:1024 sc1
    buffer_load_dwordx4 v[112:115], v34, s[8:11], s60 offen offset:2048 sc1
    buffer_load_dwordx4 v[116:119], v35, s[8:11], s60 offen offset:2048 sc1
    buffer_load_dwordx4 v[120:123], v34, s[8:11], s60 offen offset:3072 sc1
    buffer_load_dwordx4 v[124:127], v35, s[8:11], s60 offen offset:3072 sc1
    s_call_b64 s[48:49], L_pass64b
    v_cvt_pk_bf16_f32 v52, v192, v193
    v_cvt_pk_bf16_f32 v53, v194, v195
    v_cvt_pk_bf16_f32 v54, v196, v197
    v_cvt_pk_bf16_f32 v55, v198, v199
    v_cvt_pk_bf16_f32 v56, v200, v201
    v_cvt_pk_bf16_f32 v57, v202, v203
    v_cvt_pk_bf16_f32 v58, v204, v205
    v_cvt_pk_bf16_f32 v59, v206, v207
    s_add_u32 s44, s62, 6291456
    buffer_store_dwordx4 v[52:55], v10, s[8:11], s44 offen sc1
    buffer_store_dwordx4 v[56:59], v10, s[8:11], s44 offen offset:1024 sc1
    v_mov_b32 v60, 0
    v_mov_b32 v61, 0
    v_dot2_f32_bf16 v60, v52, s52, v60
    v_dot2_f32_bf16 v61, v52, v52, v61
    v_dot2_f32_bf16 v60, v53, s52, v60
    v_dot2_f32_bf16 v61, v53, v53, v61
    v_dot2_f32_bf16 v60, v54, s52, v60
    v_dot2_f32_bf16 v61, v54, v54, v61
    v_dot2_f32_bf16 v60, v55, s52, v60
    v_dot2_f32_bf16 v61, v55, v55, v61
    v_dot2_f32_bf16 v60, v56, s52, v60
    v_dot2_f32_bf16 v61, v56, v56, v61
    v_dot2_f32_bf16 v60, v57, s52, v60
    v_dot2_f32_bf16 v61, v57, v57, v61
    v_dot2_f32_bf16 v60, v58, s52, v60
    v_dot2_f32_bf16 v61, v58, v58, v61
    v_dot2_f32_bf16 v60, v59, s52, v60
    v_dot2_f32_bf16 v61, v59, v59, v61
    s_mov_b32 s44, 15859712
    s_nop 1
    v_permlane16_swap_b32 v60, v61
    v_add_f32 v60, v60, v61
    v_mov_b32 v61, v60
    s_nop 1
    v_permlane32_swap_b32 v60, v61
    v_add_f32 v60, v60, v61
    v_mov_b32 v61, v60
    s_nop 1
    v_permlane16_swap_b32 v60, v61
    buffer_store_dwordx2 v[60:61], v26, s[8:11], s44 offen sc1
    s_mov_b32 s89, 0
    s_mul_i32 s44, s67, 20480
    s_mul_i32 s45, s67, -12288
    s_add_u32 s45, s45, 16384
    v_add_u32 v32, s44, v10
    v_add_u32 v33, s45, v10
    v_add_u32 v34, 0x2000, v32
    v_add_u32 v35, 0x2000, v33
    s_mul_i32 s62, s41, 57344
    s_lshl_b32 s45, s38, 11
    s_add_u32 s62, s62, s45
    s_lshl_b32 s60, s40, 15
    s_add_u32 s60, s60, 6291456
    s_lshl_b32 s47, s41, 10
    s_add_u32 s47, s47, 15859712
    s_waitcnt vmcnt(0)
    buffer_atomic_add v251, v11, s[8:11], s63 offen offset:4 sc1
    s_barrier
    ds_read_b64_tr_b16 v[128:129], v16 offset:0
    ds_read_b64_tr_b16 v[130:131], v16 offset:2048
    ds_read_b64_tr_b16 v[132:133], v17 offset:0
    ds_read_b64_tr_b16 v[134:135], v17 offset:2048
    ds_read_b64_tr_b16 v[136:137], v18 offset:0
    ds_read_b64_tr_b16 v[138:139], v18 offset:2048
    ds_read_b64_tr_b16 v[140:141], v19 offset:0
    ds_read_b64_tr_b16 v[142:143], v19 offset:2048
    ds_read_b64_tr_b16 v[144:145], v16 offset:4096
    ds_read_b64_tr_b16 v[146:147], v16 offset:6144
    ds_read_b64_tr_b16 v[148:149], v17 offset:4096
    ds_read_b64_tr_b16 v[150:151], v17 offset:6144
    s_mov_b32 s44, 5963776
L_rdy_11:
    s_mov_b32 s56, 0
    s_atomic_add s56, s[36:37], s57 glc
    s_waitcnt lgkmcnt(0)
L_rdy_11_c:
    s_andn2_b32 s46, s44, s56
    s_cbranch_scc1 L_rdy_11_s
L_rdy_11_d:
    buffer_load_dwordx4 v[64:67], v32, s[8:11], s60 offen offset:0 sc1
    buffer_load_dwordx4 v[68:71], v33, s[8:11], s60 offen offset:0 sc1
    buffer_load_dwordx4 v[72:75], v32, s[8:11], s60 offen offset:1024 sc1
    buffer_load_dwordx4 v[76:79], v33, s[8:11], s60 offen offset:1024 sc1
    buffer_load_dwordx4 v[80:83], v32, s[8:11], s60 offen offset:2048 sc1
    buffer_load_dwordx4 v[84:87], v33, s[8:11], s60 offen offset:2048 sc1
    buffer_load_dwordx4 v[88:91], v32, s[8:11], s60 offen offset:3072 sc1
    buffer_load_dwordx4 v[92:95], v33, s[8:11], s60 offen offset:3072 sc1
    s_mov_b32 s44, 1526726656
    s_branch L_rdy_12_c
L_rdy_12:
    s_mov_b32 s56, 0
    s_atomic_add s56, s[36:37], s57 glc
    s_waitcnt lgkmcnt(0)
L_rdy_12_c:
    s_andn2_b32 s46, s44, s56
    s_cbranch_scc1 L_rdy_12_s
L_rdy_12_d:
    buffer_load_dwordx4 v[96:99], v34, s[8:11], s60 offen offset:0 sc1
    buffer_load_dwordx4 v[100:103], v35, s[8:11], s60 offen offset:0 sc1
    buffer_load_dwordx4 v[104:107], v34, s[8:11], s60 offen offset:1024 sc1
    buffer_load_dwordx4 v[108:111], v35, s[8:11], s60 offen offset:1024 sc1
    buffer_load_dwordx4 v[112:115], v34, s[8:11], s60 offen offset:2048 sc1
    buffer_load_dwordx4 v[116:119], v35, s[8:11], s60 offen offset:2048 sc1
    buffer_load_dwordx4 v[120:123], v34, s[8:11], s60 offen offset:3072 sc1
    buffer_load_dwordx4 v[124:127], v35, s[8:11], s60 offen offset:3072 sc1
    s_mov_b32 s44, 4294901760
    s_branch L_rdy_13_c
L_rdy_13:
    s_mov_b32 s56, 0
    s_atomic_add s56, s[36:37], s57 glc
    s_waitcnt lgkmcnt(0)
L_rdy_13_c:
    s_andn2_b32 s46, s44, s56
    s_cbranch_scc1 L_rdy_13_s
L_rdy_13_d:
    buffer_load_dwordx4 v[60:63], v10, s[8:11], s47 offen sc1
    s_call_b64 s[48:49], L_pass64
    v_add_f32 v5, v60, v62
    v_add_f32 v4, v61, v63
    s_nop 1
    v_permlane16_swap_b32 v5, v4
    v_add_f32 v5, v5, v4
    v_mov_b32 v4, v5
    s_nop 1
    v_permlane32_swap_b32 v5, v4
    v_add_f32 v5, v5, v4
    v_mov_b32 v4, v5
    s_nop 1
    v_permlane16_swap_b32 v5, v4
    v_mul_f32 v5, 0xbb000000, v5
    v_mul_f32 v4, 0x3b000000, v4
    v_fma_f32 v4, -v5, v5, v4
    v_max_f32 v4, 0, v4
    v_add_f32 v3, 0x3727c5ac, v4
    v_rsq_f32 v22, v3
    v_rsq_f32 v23, v3
    v_mul_f32 v240, v5, v22
    v_mul_f32 v241, v5, v22
    v_add_u32 v246, 256, v246
    s_call_b64 s[50:51], L_gelu
    s_add_u32 s44, s62, 8388608
    buffer_store_dwordx4 v[224:227], v10, s[8:11], s44 offen sc1
    buffer_store_dwordx4 v[228:231], v10, s[8:11], s44 offen offset:1024 sc1
    s_call_b64 s[48:49], L_pass64
    s_waitcnt vmcnt(0)
    buffer_atomic_add v250, v11, s[8:11], s63 offen offset:8 sc1
    v_add_u32 v246, -256, v246
    s_call_b64 s[50:51], L_gelu
    s_add_u32 s44, s62, 8404992
    buffer_store_dwordx4 v[224:227], v10, s[8:11], s44 offen sc1
    buffer_store_dwordx4 v[228:231], v10, s[8:11], s44 offen offset:1024 sc1
    s_call_b64 s[48:49], L_pass64
    s_waitcnt vmcnt(0)
    buffer_atomic_add v251, v11, s[8:11], s63 offen offset:8 sc1
    v_add_u32 v16, s61, v20
    v_add_u32 v17, s61, v21
    ds_read_b64_tr_b16 v[128:129], v16 offset:32768
    ds_read_b64_tr_b16 v[130:131], v16 offset:33792
    ds_read_b64_tr_b16 v[132:133], v17 offset:32768
    ds_read_b64_tr_b16 v[134:135], v17 offset:33792
    ds_read_b64_tr_b16 v[136:137], v16 offset:34816
    ds_read_b64_tr_b16 v[138:139], v16 offset:35840
    ds_read_b64_tr_b16 v[140:141], v17 offset:34816
    ds_read_b64_tr_b16 v[142:143], v17 offset:35840
    ds_read_b64_tr_b16 v[144:145], v16 offset:36864
    ds_read_b64_tr_b16 v[146:147], v16 offset:37888
    ds_read_b64_tr_b16 v[148:149], v17 offset:36864
    ds_read_b64_tr_b16 v[150:151], v17 offset:37888
    v_add_u32 v246, 256, v246
    s_call_b64 s[50:51], L_gelu
    s_add_u32 s44, s62, 8421376
    buffer_store_dwordx4 v[224:227], v10, s[8:11], s44 offen sc1
    buffer_store_dwordx4 v[228:231], v10, s[8:11], s44 offen offset:1024 sc1
    s_waitcnt lgkmcnt(8)
    v_mfma_f32_16x16x32_bf16 v[176:179], v[128:131], v[68:71], 0
    ds_read_b64_tr_b16 v[152:153], v16 offset:38912
    v_mfma_f32_16x16x32_bf16 v[160:163], v[128:131], v[64:67], 0
    ds_read_b64_tr_b16 v[154:155], v16 offset:39936
    v_mfma_f32_16x16x32_bf16 v[180:183], v[132:135], v[68:71], 0
    ds_read_b64_tr_b16 v[156:157], v17 offset:38912
    v_mfma_f32_16x16x32_bf16 v[164:167], v[132:135], v[64:67], 0
    ds_read_b64_tr_b16 v[158:159], v17 offset:39936
    s_waitcnt lgkmcnt(8)
    v_mfma_f32_16x16x32_bf16 v[176:179], v[136:139], v[76:79], v[176:179]
    ds_read_b64_tr_b16 v[128:129], v16 offset:40960
    v_mfma_f32_16x16x32_bf16 v[160:163], v[136:139], v[72:75], v[160:163]
    ds_read_b64_tr_b16 v[130:131], v16 offset:41984
    v_mfma_f32_16x16x32_bf16 v[180:183], v[140:143], v[76:79], v[180:183]
    ds_read_b64_tr_b16 v[132:133], v17 offset:40960
    v_mfma_f32_16x16x32_bf16 v[164:167], v[140:143], v[72:75], v[164:167]
    ds_read_b64_tr_b16 v[134:135], v17 offset:41984
    s_waitcnt lgkmcnt(8)
    v_mfma_f32_16x16x32_bf16 v[176:179], v[144:147], v[84:87], v[176:179]
    ds_read_b64_tr_b16 v[136:137], v16 offset:43008
    v_mfma_f32_16x16x32_bf16 v[160:163], v[144:147], v[80:83], v[160:163]
    ds_read_b64_tr_b16 v[138:139], v16 offset:44032
    v_mfma_f32_16x16x32_bf16 v[180:183], v[148:151], v[84:87], v[180:183]
    ds_read_b64_tr_b16 v[140:141], v17 offset:43008
    v_mfma_f32_16x16x32_bf16 v[164:167], v[148:151], v[80:83], v[164:167]
    ds_read_b64_tr_b16 v[142:143], v17 offset:44032
    s_waitcnt lgkmcnt(8)
    v_mfma_f32_16x16x32_bf16 v[176:179], v[152:155], v[92:95], v[176:179]
    ds_read_b64_tr_b16 v[144:145], v16 offset:45056
    v_mfma_f32_16x16x32_bf16 v[160:163], v[152:155], v[88:91], v[160:163]
    ds_read_b64_tr_b16 v[146:147], v16 offset:46080
    v_mfma_f32_16x16x32_bf16 v[180:183], v[156:159], v[92:95], v[180:183]
    ds_read_b64_tr_b16 v[148:149], v17 offset:45056
    v_mfma_f32_16x16x32_bf16 v[164:167], v[156:159], v[88:91], v[164:167]
    ds_read_b64_tr_b16 v[150:151], v17 offset:46080
    s_waitcnt lgkmcnt(8)
    v_mfma_f32_16x16x32_bf16 v[176:179], v[128:131], v[100:103], v[176:179]
    ds_read_b64_tr_b16 v[152:153], v16 offset:47104
    v_mfma_f32_16x16x32_bf16 v[160:163], v[128:131], v[96:99], v[160:163]
    ds_read_b64_tr_b16 v[154:155], v16 offset:48128
    v_mfma_f32_16x16x32_bf16 v[180:183], v[132:135], v[100:103], v[180:183]
    ds_read_b64_tr_b16 v[156:157], v17 offset:47104
    v_mfma_f32_16x16x32_bf16 v[164:167], v[132:135], v[96:99], v[164:167]
    ds_read_b64_tr_b16 v[158:159], v17 offset:48128
    s_waitcnt lgkmcnt(8)
    v_mfma_f32_16x16x32_bf16 v[176:179], v[136:139], v[108:111], v[176:179]
    v_mfma_f32_16x16x32_bf16 v[160:163], v[136:139], v[104:107], v[160:163]
    v_mfma_f32_16x16x32_bf16 v[180:183], v[140:143], v[108:111], v[180:183]
    v_mfma_f32_16x16x32_bf16 v[164:167], v[140:143], v[104:107], v[164:167]
    s_waitcnt lgkmcnt(4)
    v_mfma_f32_16x16x32_bf16 v[176:179], v[144:147], v[116:119], v[176:179]
    v_mfma_f32_16x16x32_bf16 v[160:163], v[144:147], v[112:115], v[160:163]
    v_mfma_f32_16x16x32_bf16 v[180:183], v[148:151], v[116:119], v[180:183]
    v_mfma_f32_16x16x32_bf16 v[164:167], v[148:151], v[112:115], v[164:167]
    s_waitcnt lgkmcnt(0)
    v_mfma_f32_16x16x32_bf16 v[176:179], v[152:155], v[124:127], v[176:179]
    v_mfma_f32_16x16x32_bf16 v[160:163], v[152:155], v[120:123], v[160:163]
    v_mfma_f32_16x16x32_bf16 v[180:183], v[156:159], v[124:127], v[180:183]
    v_mfma_f32_16x16x32_bf16 v[164:167], v[156:159], v[120:123], v[164:167]
    v_add_u32 v16, s61, v12
    v_add_u32 v17, s61, v13
    v_add_u32 v18, s61, v14
    v_add_u32 v19, s61, v15
    s_mov_b32 s43, 1
    s_nop 1
    ds_write_b128 v28, v[176:179] offset:0
    ds_write_b128 v28, v[180:183] offset:1024
    s_waitcnt vmcnt(0)
    buffer_atomic_add v250, v11, s[8:11], s63 offen offset:12 sc1
    s_mul_i32 s44, s67, 61440
    s_mul_i32 s45, s67, -53248
    s_add_u32 s45, s45, 57344
    v_add_u32 v32, s44, v10
    v_add_u32 v33, s45, v10
    v_add_u32 v34, 0x2000, v32
    v_add_u32 v35, 0x2000, v33
    s_mul_i32 s60, s40, 114688
    s_add_u32 s60, s60, 8388608
    s_add_u32 s57, s63, 8
    s_mov_b64 s[74:75], 0
    s_atomic_add_x2 s[74:75], s[36:37], s57 glc
    s_waitcnt lgkmcnt(0)
L_g_14_dc:
    s_lshr_b32 s44, s74, 0
    s_andn2_b32 s44, 0xffff, s44
    s_cbranch_scc1 L_g_14
L_g_14_d:
    buffer_load_dwordx4 v[64:67], v32, s[8:11], s60 offen offset:0 sc1
    buffer_load_dwordx4 v[68:71], v33, s[8:11], s60 offen offset:0 sc1
    buffer_load_dwordx4 v[72:75], v32, s[8:11], s60 offen offset:1024 sc1
    buffer_load_dwordx4 v[76:79], v33, s[8:11], s60 offen offset:1024 sc1
    buffer_load_dwordx4 v[80:83], v32, s[8:11], s60 offen offset:2048 sc1
    buffer_load_dwordx4 v[84:87], v33, s[8:11], s60 offen offset:2048 sc1
    buffer_load_dwordx4 v[88:91], v32, s[8:11], s60 offen offset:3072 sc1
    buffer_load_dwordx4 v[92:95], v33, s[8:11], s60 offen offset:3072 sc1
    buffer_load_dwordx4 v[96:99], v34, s[8:11], s60 offen offset:0 sc1
    buffer_load_dwordx4 v[100:103], v35, s[8:11], s60 offen offset:0 sc1
    buffer_load_dwordx4 v[104:107], v34, s[8:11], s60 offen offset:1024 sc1
    buffer_load_dwordx4 v[108:111], v35, s[8:11], s60 offen offset:1024 sc1
    buffer_load_dwordx4 v[112:115], v34, s[8:11], s60 offen offset:2048 sc1
    buffer_load_dwordx4 v[116:119], v35, s[8:11], s60 offen offset:2048 sc1
    buffer_load_dwordx4 v[120:123], v34, s[8:11], s60 offen offset:3072 sc1
    buffer_load_dwordx4 v[124:127], v35, s[8:11], s60 offen offset:3072 sc1
    s_barrier
    ds_read_b128 v[192:195], v29 offset:0
    ds_read_b128 v[196:199], v29 offset:1024
    ds_read_b128 v[176:179], v246 offset:0
    ds_read_b128 v[180:183], v246 offset:64
    ds_read_b64_tr_b16 v[128:129], v16 offset:49152
    ds_read_b64_tr_b16 v[130:131], v16 offset:51200
    ds_read_b64_tr_b16 v[132:133], v17 offset:49152
    ds_read_b64_tr_b16 v[134:135], v17 offset:51200
    ds_read_b64_tr_b16 v[136:137], v18 offset:49152
    ds_read_b64_tr_b16 v[138:139], v18 offset:51200
    ds_read_b64_tr_b16 v[140:141], v19 offset:49152
    ds_read_b64_tr_b16 v[142:143], v19 offset:51200
    ds_read_b64_tr_b16 v[144:145], v16 offset:53248
    ds_read_b64_tr_b16 v[146:147], v16 offset:55296
    ds_read_b64_tr_b16 v[148:149], v17 offset:53248
    ds_read_b64_tr_b16 v[150:151], v17 offset:55296
    s_waitcnt lgkmcnt(12)
    v_pk_add_f32 v[192:193], v[160:161], v[192:193]
    v_pk_add_f32 v[194:195], v[162:163], v[194:195]
    v_pk_add_f32 v[196:197], v[164:165], v[196:197]
    v_pk_add_f32 v[198:199], v[166:167], v[198:199]
    s_call_b64 s[50:51], L_gelu
    s_lshl_b32 s45, s38, 10
    s_sub_u32 s44, s62, s45
    s_add_u32 s44, s44, 8437760
    buffer_store_dwordx4 v[224:227], v10, s[8:11], s44 offen sc1
    v_lshlrev_b32 v192, 16, v44
    v_and_b32 v193, 0xffff0000, v44
    v_lshlrev_b32 v194, 16, v45
    v_and_b32 v195, 0xffff0000, v45
    v_lshlrev_b32 v196, 16, v46
    v_and_b32 v197, 0xffff0000, v46
    v_lshlrev_b32 v198, 16, v47
    v_and_b32 v199, 0xffff0000, v47
    v_lshlrev_b32 v200, 16, v48
    v_and_b32 v201, 0xffff0000, v48
    v_lshlrev_b32 v202, 16, v49
    v_and_b32 v203, 0xffff0000, v49
    v_lshlrev_b32 v204, 16, v50
    v_and_b32 v205, 0xffff0000, v50
    v_lshlrev_b32 v206, 16, v51
    v_and_b32 v207, 0xffff0000, v51
    v_lshlrev_b32 v208, 16, v52
    v_and_b32 v209, 0xffff0000, v52
    v_lshlrev_b32 v210, 16, v53
    v_and_b32 v211, 0xffff0000, v53
    v_lshlrev_b32 v212, 16, v54
    v_and_b32 v213, 0xffff0000, v54
    v_lshlrev_b32 v214, 16, v55
    v_and_b32 v215, 0xffff0000, v55
    v_lshlrev_b32 v216, 16, v56
    v_and_b32 v217, 0xffff0000, v56
    v_lshlrev_b32 v218, 16, v57
    v_and_b32 v219, 0xffff0000, v57
    v_lshlrev_b32 v220, 16, v58
    v_and_b32 v221, 0xffff0000, v58
    v_lshlrev_b32 v222, 16, v59
    v_and_b32 v223, 0xffff0000, v59
    v_pk_add_f32 v[160:161], v[192:193], v[208:209]
    v_pk_add_f32 v[162:163], v[194:195], v[210:211]
    v_pk_add_f32 v[164:165], v[196:197], v[212:213]
    v_pk_add_f32 v[166:167], v[198:199], v[214:215]
    v_pk_add_f32 v[168:169], v[200:201], v[216:217]
    v_pk_add_f32 v[170:171], v[202:203], v[218:219]
    v_pk_add_f32 v[172:173], v[204:205], v[220:221]
    v_pk_add_f32 v[174:175], v[206:207], v[222:223]
    v_mov_b32 v176, 0
    v_mov_b32 v177, 0
    v_mov_b32 v178, 0
    v_mov_b32 v179, 0
    v_mov_b32 v180, 0
    v_mov_b32 v181, 0
    v_mov_b32 v182, 0
    v_mov_b32 v183, 0
    v_mov_b32 v184, 0
    v_mov_b32 v185, 0
    v_mov_b32 v186, 0
    v_mov_b32 v187, 0
    v_mov_b32 v188, 0
    v_mov_b32 v189, 0
    v_mov_b32 v190, 0
    v_mov_b32 v191, 0
    s_waitcnt vmcnt(15) lgkmcnt(8)
    v_mfma_f32_16x16x32_bf16 v[160:163], v[128:131], v[64:67], v[160:163]
    ds_read_b64_tr_b16 v[152:153], v18 offset:53248
    v_mfma_f32_16x16x32_bf16 v[176:179], v[128:131], v[68:71], v[176:179]
    ds_read_b64_tr_b16 v[154:155], v18 offset:55296
    v_mfma_f32_16x16x32_bf16 v[164:167], v[132:135], v[64:67], v[164:167]
    ds_read_b64_tr_b16 v[156:157], v19 offset:53248
    v_mfma_f32_16x16x32_bf16 v[180:183], v[132:135], v[68:71], v[180:183]
    ds_read_b64_tr_b16 v[158:159], v19 offset:55296
    s_waitcnt lgkmcnt(8)
    v_mfma_f32_16x16x32_bf16 v[168:171], v[136:139], v[64:67], v[168:171]
    ds_read_b64_tr_b16 v[128:129], v16 offset:57344
    v_mfma_f32_16x16x32_bf16 v[184:187], v[136:139], v[68:71], v[184:187]
    ds_read_b64_tr_b16 v[130:131], v16 offset:59392
    v_mfma_f32_16x16x32_bf16 v[172:175], v[140:143], v[64:67], v[172:175]
    ds_read_b64_tr_b16 v[132:133], v17 offset:57344
    v_mfma_f32_16x16x32_bf16 v[188:191], v[140:143], v[68:71], v[188:191]
    ds_read_b64_tr_b16 v[134:135], v17 offset:59392
    s_waitcnt vmcnt(13) lgkmcnt(8)
    v_mfma_f32_16x16x32_bf16 v[160:163], v[144:147], v[72:75], v[160:163]
    ds_read_b64_tr_b16 v[136:137], v18 offset:57344
    v_mfma_f32_16x16x32_bf16 v[176:179], v[144:147], v[76:79], v[176:179]
    ds_read_b64_tr_b16 v[138:139], v18 offset:59392
    v_mfma_f32_16x16x32_bf16 v[164:167], v[148:151], v[72:75], v[164:167]
    ds_read_b64_tr_b16 v[140:141], v19 offset:57344
L_g_15_dc:
    s_lshr_b32 s44, s74, 16
    s_andn2_b32 s44, 0xffff, s44
    s_cbranch_scc1 L_g_15
L_g_15_d:
    s_add_u32 s60, s60, 16384
    buffer_load_dwordx4 v[64:67], v32, s[8:11], s60 offen offset:0 sc1
    v_mfma_f32_16x16x32_bf16 v[180:183], v[148:151], v[76:79], v[180:183]
    ds_read_b64_tr_b16 v[142:143], v19 offset:59392
    s_waitcnt lgkmcnt(8)
    v_mfma_f32_16x16x32_bf16 v[168:171], v[152:155], v[72:75], v[168:171]
    ds_read_b64_tr_b16 v[144:145], v16 offset:61440
    v_mfma_f32_16x16x32_bf16 v[184:187], v[152:155], v[76:79], v[184:187]
    ds_read_b64_tr_b16 v[146:147], v16 offset:63488
    v_mfma_f32_16x16x32_bf16 v[172:175], v[156:159], v[72:75], v[172:175]
    ds_read_b64_tr_b16 v[148:149], v17 offset:61440
    buffer_load_dwordx4 v[68:71], v33, s[8:11], s60 offen offset:0 sc1
    v_mfma_f32_16x16x32_bf16 v[188:191], v[156:159], v[76:79], v[188:191]
    ds_read_b64_tr_b16 v[150:151], v17 offset:63488
    s_waitcnt vmcnt(13) lgkmcnt(8)
    v_mfma_f32_16x16x32_bf16 v[160:163], v[128:131], v[80:83], v[160:163]
    ds_read_b64_tr_b16 v[152:153], v18 offset:61440
    v_mfma_f32_16x16x32_bf16 v[176:179], v[128:131], v[84:87], v[176:179]
    ds_read_b64_tr_b16 v[154:155], v18 offset:63488
    v_mfma_f32_16x16x32_bf16 v[164:167], v[132:135], v[80:83], v[164:167]
    ds_read_b64_tr_b16 v[156:157], v19 offset:61440
    buffer_load_dwordx4 v[72:75], v32, s[8:11], s60 offen offset:1024 sc1
    v_mfma_f32_16x16x32_bf16 v[180:183], v[132:135], v[84:87], v[180:183]
    ds_read_b64_tr_b16 v[158:159], v19 offset:63488
    s_waitcnt lgkmcnt(8)
    s_barrier
    v_mfma_f32_16x16x32_bf16 v[168:171], v[136:139], v[80:83], v[168:171]
    ds_read_b64_tr_b16 v[128:129], v16 offset:0
    v_mfma_f32_16x16x32_bf16 v[184:187], v[136:139], v[84:87], v[184:187]
    ds_read_b64_tr_b16 v[130:131], v16 offset:2048
    v_mfma_f32_16x16x32_bf16 v[172:175], v[140:143], v[80:83], v[172:175]
    ds_read_b64_tr_b16 v[132:133], v17 offset:0
    buffer_load_dwordx4 v[76:79], v33, s[8:11], s60 offen offset:1024 sc1
    v_mfma_f32_16x16x32_bf16 v[188:191], v[140:143], v[84:87], v[188:191]
    ds_read_b64_tr_b16 v[134:135], v17 offset:2048
    s_waitcnt vmcnt(13) lgkmcnt(8)
    v_mfma_f32_16x16x32_bf16 v[160:163], v[144:147], v[88:91], v[160:163]
    ds_read_b64_tr_b16 v[136:137], v18 offset:0
    v_mfma_f32_16x16x32_bf16 v[176:179], v[144:147], v[92:95], v[176:179]
    ds_read_b64_tr_b16 v[138:139], v18 offset:2048
    v_mfma_f32_16x16x32_bf16 v[164:167], v[148:151], v[88:91], v[164:167]
    ds_read_b64_tr_b16 v[140:141], v19 offset:0
    buffer_load_dwordx4 v[80:83], v32, s[8:11], s60 offen offset:2048 sc1
    v_mfma_f32_16x16x32_bf16 v[180:183], v[148:151], v[92:95], v[180:183]
    ds_read_b64_tr_b16 v[142:143], v19 offset:2048
    s_waitcnt lgkmcnt(8)
    v_mfma_f32_16x16x32_bf16 v[168:171], v[152:155], v[88:91], v[168:171]
    ds_read_b64_tr_b16 v[144:145], v16 offset:4096
    v_mfma_f32_16x16x32_bf16 v[184:187], v[152:155], v[92:95], v[184:187]
    ds_read_b64_tr_b16 v[146:147], v16 offset:6144
    v_mfma_f32_16x16x32_bf16 v[172:175], v[156:159], v[88:91], v[172:175]
    ds_read_b64_tr_b16 v[148:149], v17 offset:4096
    buffer_load_dwordx4 v[84:87], v33, s[8:11], s60 offen offset:2048 sc1
    v_mfma_f32_16x16x32_bf16 v[188:191], v[156:159], v[92:95], v[188:191]
    ds_read_b64_tr_b16 v[150:151], v17 offset:6144
    s_waitcnt vmcnt(13) lgkmcnt(8)
    v_mfma_f32_16x16x32_bf16 v[160:163], v[128:131], v[96:99], v[160:163]
    ds_read_b64_tr_b16 v[152:153], v18 offset:4096
    v_mfma_f32_16x16x32_bf16 v[176:179], v[128:131], v[100:103], v[176:179]
    ds_read_b64_tr_b16 v[154:155], v18 offset:6144
    v_mfma_f32_16x16x32_bf16 v[164:167], v[132:135], v[96:99], v[164:167]
    ds_read_b64_tr_b16 v[156:157], v19 offset:4096
    buffer_load_dwordx4 v[88:91], v32, s[8:11], s60 offen offset:3072 sc1
    v_mfma_f32_16x16x32_bf16 v[180:183], v[132:135], v[100:103], v[180:183]
    ds_read_b64_tr_b16 v[158:159], v19 offset:6144
    s_waitcnt lgkmcnt(8)
    v_mfma_f32_16x16x32_bf16 v[168:171], v[136:139], v[96:99], v[168:171]
    ds_read_b64_tr_b16 v[128:129], v16 offset:8192
    v_mfma_f32_16x16x32_bf16 v[184:187], v[136:139], v[100:103], v[184:187]
    ds_read_b64_tr_b16 v[130:131], v16 offset:10240
    v_mfma_f32_16x16x32_bf16 v[172:175], v[140:143], v[96:99], v[172:175]
    ds_read_b64_tr_b16 v[132:133], v17 offset:8192
    buffer_load_dwordx4 v[92:95], v33, s[8:11], s60 offen offset:3072 sc1
    v_mfma_f32_16x16x32_bf16 v[188:191], v[140:143], v[100:103], v[188:191]
    ds_read_b64_tr_b16 v[134:135], v17 offset:10240
    s_waitcnt vmcnt(13) lgkmcnt(8)
    v_mfma_f32_16x16x32_bf16 v[160:163], v[144:147], v[104:107], v[160:163]
    ds_read_b64_tr_b16 v[136:137], v18 offset:8192
    v_mfma_f32_16x16x32_bf16 v[176:179], v[144:147], v[108:111], v[176:179]
    ds_read_b64_tr_b16 v[138:139], v18 offset:10240
    v_mfma_f32_16x16x32_bf16 v[164:167], v[148:151], v[104:107], v[164:167]
    ds_read_b64_tr_b16 v[140:141], v19 offset:8192
    buffer_load_dwordx4 v[96:99], v34, s[8:11], s60 offen offset:0 sc1
    v_mfma_f32_16x16x32_bf16 v[180:183], v[148:151], v[108:111], v[180:183]
    ds_read_b64_tr_b16 v[142:143], v19 offset:10240
    s_waitcnt lgkmcnt(8)
    v_mfma_f32_16x16x32_bf16 v[168:171], v[152:155], v[104:107], v[168:171]
    ds_read_b64_tr_b16 v[144:145], v16 offset:12288
    v_mfma_f32_16x16x32_bf16 v[184:187], v[152:155], v[108:111], v[184:187]
    ds_read_b64_tr_b16 v[146:147], v16 offset:14336
    v_mfma_f32_16x16x32_bf16 v[172:175], v[156:159], v[104:107], v[172:175]
    ds_read_b64_tr_b16 v[148:149], v17 offset:12288
    buffer_load_dwordx4 v[100:103], v35, s[8:11], s60 offen offset:0 sc1
    v_mfma_f32_16x16x32_bf16 v[188:191], v[156:159], v[108:111], v[188:191]
    ds_read_b64_tr_b16 v[150:151], v17 offset:14336
    s_waitcnt vmcnt(13) lgkmcnt(8)
    v_mfma_f32_16x16x32_bf16 v[160:163], v[128:131], v[112:115], v[160:163]
    ds_read_b64_tr_b16 v[152:153], v18 offset:12288
    v_mfma_f32_16x16x32_bf16 v[176:179], v[128:131], v[116:119], v[176:179]
    ds_read_b64_tr_b16 v[154:155], v18 offset:14336
    v_mfma_f32_16x16x32_bf16 v[164:167], v[132:135], v[112:115], v[164:167]
    ds_read_b64_tr_b16 v[156:157], v19 offset:12288
    buffer_load_dwordx4 v[104:107], v34, s[8:11], s60 offen offset:1024 sc1
    v_mfma_f32_16x16x32_bf16 v[180:183], v[132:135], v[116:119], v[180:183]
    ds_read_b64_tr_b16 v[158:159], v19 offset:14336
    s_waitcnt lgkmcnt(8)
    s_barrier
    v_mfma_f32_16x16x32_bf16 v[168:171], v[136:139], v[112:115], v[168:171]
    ds_read_b64_tr_b16 v[128:129], v16 offset:16384
    v_mfma_f32_16x16x32_bf16 v[184:187], v[136:139], v[116:119], v[184:187]
    ds_read_b64_tr_b16 v[130:131], v16 offset:18432
    v_mfma_f32_16x16x32_bf16 v[172:175], v[140:143], v[112:115], v[172:175]
    ds_read_b64_tr_b16 v[132:133], v17 offset:16384
    buffer_load_dwordx4 v[108:111], v35, s[8:11], s60 offen offset:1024 sc1
    v_mfma_f32_16x16x32_bf16 v[188:191], v[140:143], v[116:119], v[188:191]
    ds_read_b64_tr_b16 v[134:135], v17 offset:18432
    s_waitcnt vmcnt(13) lgkmcnt(8)
    v_mfma_f32_16x16x32_bf16 v[160:163], v[144:147], v[120:123], v[160:163]
    ds_read_b64_tr_b16 v[136:137], v18 offset:16384
    v_mfma_f32_16x16x32_bf16 v[176:179], v[144:147], v[124:127], v[176:179]
    ds_read_b64_tr_b16 v[138:139], v18 offset:18432
    v_mfma_f32_16x16x32_bf16 v[164:167], v[148:151], v[120:123], v[164:167]
    ds_read_b64_tr_b16 v[140:141], v19 offset:16384
    buffer_load_dwordx4 v[112:115], v34, s[8:11], s60 offen offset:2048 sc1
    v_mfma_f32_16x16x32_bf16 v[180:183], v[148:151], v[124:127], v[180:183]
    ds_read_b64_tr_b16 v[142:143], v19 offset:18432
    s_waitcnt lgkmcnt(8)
    v_mfma_f32_16x16x32_bf16 v[168:171], v[152:155], v[120:123], v[168:171]
    ds_read_b64_tr_b16 v[144:145], v16 offset:20480
    v_mfma_f32_16x16x32_bf16 v[184:187], v[152:155], v[124:127], v[184:187]
    ds_read_b64_tr_b16 v[146:147], v16 offset:22528
    v_mfma_f32_16x16x32_bf16 v[172:175], v[156:159], v[120:123], v[172:175]
    ds_read_b64_tr_b16 v[148:149], v17 offset:20480
    buffer_load_dwordx4 v[116:119], v35, s[8:11], s60 offen offset:2048 sc1
    v_mfma_f32_16x16x32_bf16 v[188:191], v[156:159], v[124:127], v[188:191]
    ds_read_b64_tr_b16 v[150:151], v17 offset:22528
    s_waitcnt vmcnt(12) lgkmcnt(8)
    s_waitcnt vmcnt(14)
    buffer_atomic_add v251, v11, s[8:11], s63 offen offset:12 sc1
    v_mfma_f32_16x16x32_bf16 v[160:163], v[128:131], v[64:67], v[160:163]
    ds_read_b64_tr_b16 v[152:153], v18 offset:20480
    v_mfma_f32_16x16x32_bf16 v[176:179], v[128:131], v[68:71], v[176:179]
    ds_read_b64_tr_b16 v[154:155], v18 offset:22528
    v_mfma_f32_16x16x32_bf16 v[164:167], v[132:135], v[64:67], v[164:167]
    ds_read_b64_tr_b16 v[156:157], v19 offset:20480
    buffer_load_dwordx4 v[120:123], v34, s[8:11], s60 offen offset:3072 sc1
    v_mfma_f32_16x16x32_bf16 v[180:183], v[132:135], v[68:71], v[180:183]
    ds_read_b64_tr_b16 v[158:159], v19 offset:22528
    s_waitcnt lgkmcnt(8)
    v_mfma_f32_16x16x32_bf16 v[168:171], v[136:139], v[64:67], v[168:171]
    ds_read_b64_tr_b16 v[128:129], v16 offset:24576
    v_mfma_f32_16x16x32_bf16 v[184:187], v[136:139], v[68:71], v[184:187]
    ds_read_b64_tr_b16 v[130:131], v16 offset:26624
    v_mfma_f32_16x16x32_bf16 v[172:175], v[140:143], v[64:67], v[172:175]
    ds_read_b64_tr_b16 v[132:133], v17 offset:24576
    buffer_load_dwordx4 v[124:127], v35, s[8:11], s60 offen offset:3072 sc1
    v_mfma_f32_16x16x32_bf16 v[188:191], v[140:143], v[68:71], v[188:191]
    ds_read_b64_tr_b16 v[134:135], v17 offset:26624
    s_waitcnt vmcnt(13) lgkmcnt(8)
    v_mfma_f32_16x16x32_bf16 v[160:163], v[144:147], v[72:75], v[160:163]
    ds_read_b64_tr_b16 v[136:137], v18 offset:24576
    v_mfma_f32_16x16x32_bf16 v[176:179], v[144:147], v[76:79], v[176:179]
    ds_read_b64_tr_b16 v[138:139], v18 offset:26624
    v_mfma_f32_16x16x32_bf16 v[164:167], v[148:151], v[72:75], v[164:167]
    ds_read_b64_tr_b16 v[140:141], v19 offset:24576
L_g_16_dc:
    s_lshr_b32 s44, s75, 0
    s_andn2_b32 s44, 0xffff, s44
    s_cbranch_scc1 L_g_16
L_g_16_d:
    s_add_u32 s60, s60, 16384
    buffer_load_dwordx4 v[64:67], v32, s[8:11], s60 offen offset:0 sc1
    v_mfma_f32_16x16x32_bf16 v[180:183], v[148:151], v[76:79], v[180:183]
    ds_read_b64_tr_b16 v[142:143], v19 offset:26624
    s_waitcnt lgkmcnt(8)
    v_mfma_f32_16x16x32_bf16 v[168:171], v[152:155], v[72:75], v[168:171]
    ds_read_b64_tr_b16 v[144:145], v16 offset:28672
    v_mfma_f32_16x16x32_bf16 v[184:187], v[152:155], v[76:79], v[184:187]
    ds_read_b64_tr_b16 v[146:147], v16 offset:30720
    v_mfma_f32_16x16x32_bf16 v[172:175], v[156:159], v[72:75], v[172:175]
    ds_read_b64_tr_b16 v[148:149], v17 offset:28672
    buffer_load_dwordx4 v[68:71], v33, s[8:11], s60 offen offset:0 sc1
    v_mfma_f32_16x16x32_bf16 v[188:191], v[156:159], v[76:79], v[188:191]
    ds_read_b64_tr_b16 v[150:151], v17 offset:30720
    s_waitcnt vmcnt(13) lgkmcnt(8)
    v_mfma_f32_16x16x32_bf16 v[160:163], v[128:131], v[80:83], v[160:163]
    ds_read_b64_tr_b16 v[152:153], v18 offset:28672
    v_mfma_f32_16x16x32_bf16 v[176:179], v[128:131], v[84:87], v[176:179]
    ds_read_b64_tr_b16 v[154:155], v18 offset:30720
    v_mfma_f32_16x16x32_bf16 v[164:167], v[132:135], v[80:83], v[164:167]
    ds_read_b64_tr_b16 v[156:157], v19 offset:28672
    buffer_load_dwordx4 v[72:75], v32, s[8:11], s60 offen offset:1024 sc1
    v_mfma_f32_16x16x32_bf16 v[180:183], v[132:135], v[84:87], v[180:183]
    ds_read_b64_tr_b16 v[158:159], v19 offset:30720
    s_waitcnt lgkmcnt(8)
    s_barrier
    v_mfma_f32_16x16x32_bf16 v[168:171], v[136:139], v[80:83], v[168:171]
    ds_read_b64_tr_b16 v[128:129], v16 offset:32768
    v_mfma_f32_16x16x32_bf16 v[184:187], v[136:139], v[84:87], v[184:187]
    ds_read_b64_tr_b16 v[130:131], v16 offset:34816
    v_mfma_f32_16x16x32_bf16 v[172:175], v[140:143], v[80:83], v[172:175]
    ds_read_b64_tr_b16 v[132:133], v17 offset:32768
    buffer_load_dwordx4 v[76:79], v33, s[8:11], s60 offen offset:1024 sc1
    v_mfma_f32_16x16x32_bf16 v[188:191], v[140:143], v[84:87], v[188:191]
    ds_read_b64_tr_b16 v[134:135], v17 offset:34816
    s_waitcnt vmcnt(13) lgkmcnt(8)
    v_mfma_f32_16x16x32_bf16 v[160:163], v[144:147], v[88:91], v[160:163]
    ds_read_b64_tr_b16 v[136:137], v18 offset:32768
    v_mfma_f32_16x16x32_bf16 v[176:179], v[144:147], v[92:95], v[176:179]
    ds_read_b64_tr_b16 v[138:139], v18 offset:34816
    v_mfma_f32_16x16x32_bf16 v[164:167], v[148:151], v[88:91], v[164:167]
    ds_read_b64_tr_b16 v[140:141], v19 offset:32768
    buffer_load_dwordx4 v[80:83], v32, s[8:11], s60 offen offset:2048 sc1
    v_mfma_f32_16x16x32_bf16 v[180:183], v[148:151], v[92:95], v[180:183]
    ds_read_b64_tr_b16 v[142:143], v19 offset:34816
    s_waitcnt lgkmcnt(8)
    v_mfma_f32_16x16x32_bf16 v[168:171], v[152:155], v[88:91], v[168:171]
    ds_read_b64_tr_b16 v[144:145], v16 offset:36864
    v_mfma_f32_16x16x32_bf16 v[184:187], v[152:155], v[92:95], v[184:187]
    ds_read_b64_tr_b16 v[146:147], v16 offset:38912
    v_mfma_f32_16x16x32_bf16 v[172:175], v[156:159], v[88:91], v[172:175]
    ds_read_b64_tr_b16 v[148:149], v17 offset:36864
    buffer_load_dwordx4 v[84:87], v33, s[8:11], s60 offen offset:2048 sc1
    v_mfma_f32_16x16x32_bf16 v[188:191], v[156:159], v[92:95], v[188:191]
    ds_read_b64_tr_b16 v[150:151], v17 offset:38912
    s_waitcnt vmcnt(13) lgkmcnt(8)
    v_mfma_f32_16x16x32_bf16 v[160:163], v[128:131], v[96:99], v[160:163]
    ds_read_b64_tr_b16 v[152:153], v18 offset:36864
    v_mfma_f32_16x16x32_bf16 v[176:179], v[128:131], v[100:103], v[176:179]
    ds_read_b64_tr_b16 v[154:155], v18 offset:38912
    v_mfma_f32_16x16x32_bf16 v[164:167], v[132:135], v[96:99], v[164:167]
    ds_read_b64_tr_b16 v[156:157], v19 offset:36864
    buffer_load_dwordx4 v[88:91], v32, s[8:11], s60 offen offset:3072 sc1
    v_mfma_f32_16x16x32_bf16 v[180:183], v[132:135], v[100:103], v[180:183]
    ds_read_b64_tr_b16 v[158:159], v19 offset:38912
    s_waitcnt lgkmcnt(8)
    v_mfma_f32_16x16x32_bf16 v[168:171], v[136:139], v[96:99], v[168:171]
    ds_read_b64_tr_b16 v[128:129], v16 offset:40960
    v_mfma_f32_16x16x32_bf16 v[184:187], v[136:139], v[100:103], v[184:187]
    ds_read_b64_tr_b16 v[130:131], v16 offset:43008
    v_mfma_f32_16x16x32_bf16 v[172:175], v[140:143], v[96:99], v[172:175]
    ds_read_b64_tr_b16 v[132:133], v17 offset:40960
    buffer_load_dwordx4 v[92:95], v33, s[8:11], s60 offen offset:3072 sc1
    v_mfma_f32_16x16x32_bf16 v[188:191], v[140:143], v[100:103], v[188:191]
    ds_read_b64_tr_b16 v[134:135], v17 offset:43008
    s_waitcnt vmcnt(13) lgkmcnt(8)
    v_mfma_f32_16x16x32_bf16 v[160:163], v[144:147], v[104:107], v[160:163]
    ds_read_b64_tr_b16 v[136:137], v18 offset:40960
    v_mfma_f32_16x16x32_bf16 v[176:179], v[144:147], v[108:111], v[176:179]
    ds_read_b64_tr_b16 v[138:139], v18 offset:43008
    v_mfma_f32_16x16x32_bf16 v[164:167], v[148:151], v[104:107], v[164:167]
    ds_read_b64_tr_b16 v[140:141], v19 offset:40960
    buffer_load_dwordx4 v[96:99], v34, s[8:11], s60 offen offset:0 sc1
    v_mfma_f32_16x16x32_bf16 v[180:183], v[148:151], v[108:111], v[180:183]
    ds_read_b64_tr_b16 v[142:143], v19 offset:43008
    s_waitcnt lgkmcnt(8)
    v_mfma_f32_16x16x32_bf16 v[168:171], v[152:155], v[104:107], v[168:171]
    ds_read_b64_tr_b16 v[144:145], v16 offset:45056
    v_mfma_f32_16x16x32_bf16 v[184:187], v[152:155], v[108:111], v[184:187]
    ds_read_b64_tr_b16 v[146:147], v16 offset:47104
    v_mfma_f32_16x16x32_bf16 v[172:175], v[156:159], v[104:107], v[172:175]
    ds_read_b64_tr_b16 v[148:149], v17 offset:45056
    buffer_load_dwordx4 v[100:103], v35, s[8:11], s60 offen offset:0 sc1
    v_mfma_f32_16x16x32_bf16 v[188:191], v[156:159], v[108:111], v[188:191]
    ds_read_b64_tr_b16 v[150:151], v17 offset:47104
    s_waitcnt vmcnt(13) lgkmcnt(8)
    v_mfma_f32_16x16x32_bf16 v[160:163], v[128:131], v[112:115], v[160:163]
    ds_read_b64_tr_b16 v[152:153], v18 offset:45056
    v_mfma_f32_16x16x32_bf16 v[176:179], v[128:131], v[116:119], v[176:179]
    ds_read_b64_tr_b16 v[154:155], v18 offset:47104
    v_mfma_f32_16x16x32_bf16 v[164:167], v[132:135], v[112:115], v[164:167]
    ds_read_b64_tr_b16 v[156:157], v19 offset:45056
    buffer_load_dwordx4 v[104:107], v34, s[8:11], s60 offen offset:1024 sc1
    v_mfma_f32_16x16x32_bf16 v[180:183], v[132:135], v[116:119], v[180:183]
    ds_read_b64_tr_b16 v[158:159], v19 offset:47104
    s_waitcnt lgkmcnt(8)
    s_barrier
    v_mfma_f32_16x16x32_bf16 v[168:171], v[136:139], v[112:115], v[168:171]
    ds_read_b64_tr_b16 v[128:129], v16 offset:49152
    v_mfma_f32_16x16x32_bf16 v[184:187], v[136:139], v[116:119], v[184:187]
    ds_read_b64_tr_b16 v[130:131], v16 offset:51200
    v_mfma_f32_16x16x32_bf16 v[172:175], v[140:143], v[112:115], v[172:175]
    ds_read_b64_tr_b16 v[132:133], v17 offset:49152
    buffer_load_dwordx4 v[108:111], v35, s[8:11], s60 offen offset:1024 sc1
    v_mfma_f32_16x16x32_bf16 v[188:191], v[140:143], v[116:119], v[188:191]
    ds_read_b64_tr_b16 v[134:135], v17 offset:51200
    s_waitcnt vmcnt(12) lgkmcnt(8)
    v_mfma_f32_16x16x32_bf16 v[160:163], v[144:147], v[120:123], v[160:163]
    ds_read_b64_tr_b16 v[136:137], v18 offset:49152
    v_mfma_f32_16x16x32_bf16 v[176:179], v[144:147], v[124:127], v[176:179]
    ds_read_b64_tr_b16 v[138:139], v18 offset:51200
    v_mfma_f32_16x16x32_bf16 v[164:167], v[148:151], v[120:123], v[164:167]
    ds_read_b64_tr_b16 v[140:141], v19 offset:49152
    buffer_load_dwordx4 v[112:115], v34, s[8:11], s60 offen offset:2048 sc1
    v_mfma_f32_16x16x32_bf16 v[180:183], v[148:151], v[124:127], v[180:183]
    ds_read_b64_tr_b16 v[142:143], v19 offset:51200
    s_waitcnt lgkmcnt(8)
    v_mfma_f32_16x16x32_bf16 v[168:171], v[152:155], v[120:123], v[168:171]
    ds_read_b64_tr_b16 v[144:145], v16 offset:53248
    v_mfma_f32_16x16x32_bf16 v[184:187], v[152:155], v[124:127], v[184:187]
    ds_read_b64_tr_b16 v[146:147], v16 offset:55296
    v_mfma_f32_16x16x32_bf16 v[172:175], v[156:159], v[120:123], v[172:175]
    ds_read_b64_tr_b16 v[148:149], v17 offset:53248
    buffer_load_dwordx4 v[116:119], v35, s[8:11], s60 offen offset:2048 sc1
    v_mfma_f32_16x16x32_bf16 v[188:191], v[156:159], v[124:127], v[188:191]
    ds_read_b64_tr_b16 v[150:151], v17 offset:55296
    s_waitcnt vmcnt(12) lgkmcnt(8)
    v_mfma_f32_16x16x32_bf16 v[160:163], v[128:131], v[64:67], v[160:163]
    ds_read_b64_tr_b16 v[152:153], v18 offset:53248
    v_mfma_f32_16x16x32_bf16 v[176:179], v[128:131], v[68:71], v[176:179]
    ds_read_b64_tr_b16 v[154:155], v18 offset:55296
    v_mfma_f32_16x16x32_bf16 v[164:167], v[132:135], v[64:67], v[164:167]
    ds_read_b64_tr_b16 v[156:157], v19 offset:53248
    buffer_load_dwordx4 v[120:123], v34, s[8:11], s60 offen offset:3072 sc1
    v_mfma_f32_16x16x32_bf16 v[180:183], v[132:135], v[68:71], v[180:183]
    ds_read_b64_tr_b16 v[158:159], v19 offset:55296
    s_waitcnt lgkmcnt(8)
    v_mfma_f32_16x16x32_bf16 v[168:171], v[136:139], v[64:67], v[168:171]
    ds_read_b64_tr_b16 v[128:129], v16 offset:57344
    v_mfma_f32_16x16x32_bf16 v[184:187], v[136:139], v[68:71], v[184:187]
    ds_read_b64_tr_b16 v[130:131], v16 offset:59392
    v_mfma_f32_16x16x32_bf16 v[172:175], v[140:143], v[64:67], v[172:175]
    ds_read_b64_tr_b16 v[132:133], v17 offset:57344
    buffer_load_dwordx4 v[124:127], v35, s[8:11], s60 offen offset:3072 sc1
    v_mfma_f32_16x16x32_bf16 v[188:191], v[140:143], v[68:71], v[188:191]
    ds_read_b64_tr_b16 v[134:135], v17 offset:59392
    s_waitcnt vmcnt(12) lgkmcnt(8)
    v_mfma_f32_16x16x32_bf16 v[160:163], v[144:147], v[72:75], v[160:163]
    ds_read_b64_tr_b16 v[136:137], v18 offset:57344
    v_mfma_f32_16x16x32_bf16 v[176:179], v[144:147], v[76:79], v[176:179]
    ds_read_b64_tr_b16 v[138:139], v18 offset:59392
    v_mfma_f32_16x16x32_bf16 v[164:167], v[148:151], v[72:75], v[164:167]
    ds_read_b64_tr_b16 v[140:141], v19 offset:57344
L_g_17_dc:
    s_lshr_b32 s44, s75, 16
    s_andn2_b32 s44, 0xffff, s44
    s_cbranch_scc1 L_g_17
L_g_17_d:
    s_add_u32 s60, s60, 16384
    buffer_load_dwordx4 v[64:67], v32, s[8:11], s60 offen offset:0 sc1
    v_mfma_f32_16x16x32_bf16 v[180:183], v[148:151], v[76:79], v[180:183]
    ds_read_b64_tr_b16 v[142:143], v19 offset:59392
    s_waitcnt lgkmcnt(8)
    v_mfma_f32_16x16x32_bf16 v[168:171], v[152:155], v[72:75], v[168:171]
    ds_read_b64_tr_b16 v[144:145], v16 offset:61440
    v_mfma_f32_16x16x32_bf16 v[184:187], v[152:155], v[76:79], v[184:187]
    ds_read_b64_tr_b16 v[146:147], v16 offset:63488
    v_mfma_f32_16x16x32_bf16 v[172:175], v[156:159], v[72:75], v[172:175]
    ds_read_b64_tr_b16 v[148:149], v17 offset:61440
    buffer_load_dwordx4 v[68:71], v33, s[8:11], s60 offen offset:0 sc1
    v_mfma_f32_16x16x32_bf16 v[188:191], v[156:159], v[76:79], v[188:191]
    ds_read_b64_tr_b16 v[150:151], v17 offset:63488
    s_waitcnt vmcnt(12) lgkmcnt(8)
    v_mfma_f32_16x16x32_bf16 v[160:163], v[128:131], v[80:83], v[160:163]
    ds_read_b64_tr_b16 v[152:153], v18 offset:61440
    v_mfma_f32_16x16x32_bf16 v[176:179], v[128:131], v[84:87], v[176:179]
    ds_read_b64_tr_b16 v[154:155], v18 offset:63488
    v_mfma_f32_16x16x32_bf16 v[164:167], v[132:135], v[80:83], v[164:167]
    ds_read_b64_tr_b16 v[156:157], v19 offset:61440
    buffer_load_dwordx4 v[72:75], v32, s[8:11], s60 offen offset:1024 sc1
    v_mfma_f32_16x16x32_bf16 v[180:183], v[132:135], v[84:87], v[180:183]
    ds_read_b64_tr_b16 v[158:159], v19 offset:63488
    s_waitcnt lgkmcnt(8)
    s_barrier
    v_mfma_f32_16x16x32_bf16 v[168:171], v[136:139], v[80:83], v[168:171]
    ds_read_b64_tr_b16 v[128:129], v16 offset:0
    v_mfma_f32_16x16x32_bf16 v[184:187], v[136:139], v[84:87], v[184:187]
    ds_read_b64_tr_b16 v[130:131], v16 offset:2048
    v_mfma_f32_16x16x32_bf16 v[172:175], v[140:143], v[80:83], v[172:175]
    ds_read_b64_tr_b16 v[132:133], v17 offset:0
    buffer_load_dwordx4 v[76:79], v33, s[8:11], s60 offen offset:1024 sc1
    v_mfma_f32_16x16x32_bf16 v[188:191], v[140:143], v[84:87], v[188:191]
    ds_read_b64_tr_b16 v[134:135], v17 offset:2048
    s_waitcnt vmcnt(12) lgkmcnt(8)
    v_mfma_f32_16x16x32_bf16 v[160:163], v[144:147], v[88:91], v[160:163]
    ds_read_b64_tr_b16 v[136:137], v18 offset:0
    v_mfma_f32_16x16x32_bf16 v[176:179], v[144:147], v[92:95], v[176:179]
    ds_read_b64_tr_b16 v[138:139], v18 offset:2048
    v_mfma_f32_16x16x32_bf16 v[164:167], v[148:151], v[88:91], v[164:167]
    ds_read_b64_tr_b16 v[140:141], v19 offset:0
    buffer_load_dwordx4 v[80:83], v32, s[8:11], s60 offen offset:2048 sc1
    v_mfma_f32_16x16x32_bf16 v[180:183], v[148:151], v[92:95], v[180:183]
    ds_read_b64_tr_b16 v[142:143], v19 offset:2048
    s_waitcnt lgkmcnt(8)
    v_mfma_f32_16x16x32_bf16 v[168:171], v[152:155], v[88:91], v[168:171]
    ds_read_b64_tr_b16 v[144:145], v16 offset:4096
    v_mfma_f32_16x16x32_bf16 v[184:187], v[152:155], v[92:95], v[184:187]
    ds_read_b64_tr_b16 v[146:147], v16 offset:6144
    v_mfma_f32_16x16x32_bf16 v[172:175], v[156:159], v[88:91], v[172:175]
    ds_read_b64_tr_b16 v[148:149], v17 offset:4096
    buffer_load_dwordx4 v[84:87], v33, s[8:11], s60 offen offset:2048 sc1
    v_mfma_f32_16x16x32_bf16 v[188:191], v[156:159], v[92:95], v[188:191]
    ds_read_b64_tr_b16 v[150:151], v17 offset:6144
    s_waitcnt vmcnt(12) lgkmcnt(8)
    v_mfma_f32_16x16x32_bf16 v[160:163], v[128:131], v[96:99], v[160:163]
    ds_read_b64_tr_b16 v[152:153], v18 offset:4096
    v_mfma_f32_16x16x32_bf16 v[176:179], v[128:131], v[100:103], v[176:179]
    ds_read_b64_tr_b16 v[154:155], v18 offset:6144
    v_mfma_f32_16x16x32_bf16 v[164:167], v[132:135], v[96:99], v[164:167]
    ds_read_b64_tr_b16 v[156:157], v19 offset:4096
    buffer_load_dwordx4 v[88:91], v32, s[8:11], s60 offen offset:3072 sc1
    v_mfma_f32_16x16x32_bf16 v[180:183], v[132:135], v[100:103], v[180:183]
    ds_read_b64_tr_b16 v[158:159], v19 offset:6144
    s_waitcnt lgkmcnt(8)
    v_mfma_f32_16x16x32_bf16 v[168:171], v[136:139], v[96:99], v[168:171]
    ds_read_b64_tr_b16 v[128:129], v16 offset:8192
    v_mfma_f32_16x16x32_bf16 v[184:187], v[136:139], v[100:103], v[184:187]
    ds_read_b64_tr_b16 v[130:131], v16 offset:10240
    v_mfma_f32_16x16x32_bf16 v[172:175], v[140:143], v[96:99], v[172:175]
    ds_read_b64_tr_b16 v[132:133], v17 offset:8192
    buffer_load_dwordx4 v[92:95], v33, s[8:11], s60 offen offset:3072 sc1
    v_mfma_f32_16x16x32_bf16 v[188:191], v[140:143], v[100:103], v[188:191]
    ds_read_b64_tr_b16 v[134:135], v17 offset:10240
    s_waitcnt vmcnt(12) lgkmcnt(8)
    v_mfma_f32_16x16x32_bf16 v[160:163], v[144:147], v[104:107], v[160:163]
    ds_read_b64_tr_b16 v[136:137], v18 offset:8192
    v_mfma_f32_16x16x32_bf16 v[176:179], v[144:147], v[108:111], v[176:179]
    ds_read_b64_tr_b16 v[138:139], v18 offset:10240
    v_mfma_f32_16x16x32_bf16 v[164:167], v[148:151], v[104:107], v[164:167]
    ds_read_b64_tr_b16 v[140:141], v19 offset:8192
    v_mfma_f32_16x16x32_bf16 v[180:183], v[148:151], v[108:111], v[180:183]
    ds_read_b64_tr_b16 v[142:143], v19 offset:10240
    s_waitcnt lgkmcnt(8)
    v_mfma_f32_16x16x32_bf16 v[168:171], v[152:155], v[104:107], v[168:171]
    ds_read_b64_tr_b16 v[144:145], v16 offset:12288
    v_mfma_f32_16x16x32_bf16 v[184:187], v[152:155], v[108:111], v[184:187]
    ds_read_b64_tr_b16 v[146:147], v16 offset:14336
    v_mfma_f32_16x16x32_bf16 v[172:175], v[156:159], v[104:107], v[172:175]
    ds_read_b64_tr_b16 v[148:149], v17 offset:12288
    v_mfma_f32_16x16x32_bf16 v[188:191], v[156:159], v[108:111], v[188:191]
    ds_read_b64_tr_b16 v[150:151], v17 offset:14336
    s_waitcnt vmcnt(10) lgkmcnt(8)
    v_mfma_f32_16x16x32_bf16 v[160:163], v[128:131], v[112:115], v[160:163]
    ds_read_b64_tr_b16 v[152:153], v18 offset:12288
    v_mfma_f32_16x16x32_bf16 v[176:179], v[128:131], v[116:119], v[176:179]
    ds_read_b64_tr_b16 v[154:155], v18 offset:14336
    v_mfma_f32_16x16x32_bf16 v[164:167], v[132:135], v[112:115], v[164:167]
    ds_read_b64_tr_b16 v[156:157], v19 offset:12288
    v_mfma_f32_16x16x32_bf16 v[180:183], v[132:135], v[116:119], v[180:183]
    ds_read_b64_tr_b16 v[158:159], v19 offset:14336
    s_waitcnt lgkmcnt(8)
    s_barrier
    v_mfma_f32_16x16x32_bf16 v[168:171], v[136:139], v[112:115], v[168:171]
    ds_read_b64_tr_b16 v[128:129], v16 offset:16384
    v_mfma_f32_16x16x32_bf16 v[184:187], v[136:139], v[116:119], v[184:187]
    ds_read_b64_tr_b16 v[130:131], v16 offset:18432
    v_mfma_f32_16x16x32_bf16 v[172:175], v[140:143], v[112:115], v[172:175]
    ds_read_b64_tr_b16 v[132:133], v17 offset:16384
    v_mfma_f32_16x16x32_bf16 v[188:191], v[140:143], v[116:119], v[188:191]
    ds_read_b64_tr_b16 v[134:135], v17 offset:18432
    s_waitcnt vmcnt(8) lgkmcnt(8)
    v_mfma_f32_16x16x32_bf16 v[160:163], v[144:147], v[120:123], v[160:163]
    ds_read_b64_tr_b16 v[136:137], v18 offset:16384
    v_mfma_f32_16x16x32_bf16 v[176:179], v[144:147], v[124:127], v[176:179]
    ds_read_b64_tr_b16 v[138:139], v18 offset:18432
    v_mfma_f32_16x16x32_bf16 v[164:167], v[148:151], v[120:123], v[164:167]
    ds_read_b64_tr_b16 v[140:141], v19 offset:16384
    v_mfma_f32_16x16x32_bf16 v[180:183], v[148:151], v[124:127], v[180:183]
    ds_read_b64_tr_b16 v[142:143], v19 offset:18432
    s_waitcnt lgkmcnt(8)
    v_mfma_f32_16x16x32_bf16 v[168:171], v[152:155], v[120:123], v[168:171]
    ds_read_b64_tr_b16 v[144:145], v16 offset:20480
    v_mfma_f32_16x16x32_bf16 v[184:187], v[152:155], v[124:127], v[184:187]
    ds_read_b64_tr_b16 v[146:147], v16 offset:22528
    v_mfma_f32_16x16x32_bf16 v[172:175], v[156:159], v[120:123], v[172:175]
    ds_read_b64_tr_b16 v[148:149], v17 offset:20480
    v_mfma_f32_16x16x32_bf16 v[188:191], v[156:159], v[124:127], v[188:191]
    ds_read_b64_tr_b16 v[150:151], v17 offset:22528
    s_waitcnt vmcnt(6) lgkmcnt(8)
    v_mfma_f32_16x16x32_bf16 v[160:163], v[128:131], v[64:67], v[160:163]
    ds_read_b64_tr_b16 v[152:153], v18 offset:20480
    v_mfma_f32_16x16x32_bf16 v[176:179], v[128:131], v[68:71], v[176:179]
    ds_read_b64_tr_b16 v[154:155], v18 offset:22528
    v_mfma_f32_16x16x32_bf16 v[164:167], v[132:135], v[64:67], v[164:167]
    ds_read_b64_tr_b16 v[156:157], v19 offset:20480
    v_mfma_f32_16x16x32_bf16 v[180:183], v[132:135], v[68:71], v[180:183]
    ds_read_b64_tr_b16 v[158:159], v19 offset:22528
    s_waitcnt lgkmcnt(8)
    v_mfma_f32_16x16x32_bf16 v[168:171], v[136:139], v[64:67], v[168:171]
    ds_read_b64_tr_b16 v[128:129], v16 offset:24576
    v_mfma_f32_16x16x32_bf16 v[184:187], v[136:139], v[68:71], v[184:187]
    ds_read_b64_tr_b16 v[130:131], v16 offset:26624
    v_mfma_f32_16x16x32_bf16 v[172:175], v[140:143], v[64:67], v[172:175]
    ds_read_b64_tr_b16 v[132:133], v17 offset:24576
    v_mfma_f32_16x16x32_bf16 v[188:191], v[140:143], v[68:71], v[188:191]
    ds_read_b64_tr_b16 v[134:135], v17 offset:26624
    s_waitcnt vmcnt(4) lgkmcnt(8)
    v_mfma_f32_16x16x32_bf16 v[160:163], v[144:147], v[72:75], v[160:163]
    ds_read_b64_tr_b16 v[136:137], v18 offset:24576
    v_mfma_f32_16x16x32_bf16 v[176:179], v[144:147], v[76:79], v[176:179]
    ds_read_b64_tr_b16 v[138:139], v18 offset:26624
    v_mfma_f32_16x16x32_bf16 v[164:167], v[148:151], v[72:75], v[164:167]
    ds_read_b64_tr_b16 v[140:141], v19 offset:24576
    v_mfma_f32_16x16x32_bf16 v[180:183], v[148:151], v[76:79], v[180:183]
    ds_read_b64_tr_b16 v[142:143], v19 offset:26624
    s_waitcnt lgkmcnt(8)
    v_mfma_f32_16x16x32_bf16 v[168:171], v[152:155], v[72:75], v[168:171]
    ds_read_b64_tr_b16 v[144:145], v16 offset:28672
    v_mfma_f32_16x16x32_bf16 v[184:187], v[152:155], v[76:79], v[184:187]
    ds_read_b64_tr_b16 v[146:147], v16 offset:30720
    v_mfma_f32_16x16x32_bf16 v[172:175], v[156:159], v[72:75], v[172:175]
    ds_read_b64_tr_b16 v[148:149], v17 offset:28672
    v_mfma_f32_16x16x32_bf16 v[188:191], v[156:159], v[76:79], v[188:191]
    ds_read_b64_tr_b16 v[150:151], v17 offset:30720
    s_waitcnt vmcnt(2) lgkmcnt(8)
    v_mfma_f32_16x16x32_bf16 v[160:163], v[128:131], v[80:83], v[160:163]
    ds_read_b64_tr_b16 v[152:153], v18 offset:28672
    v_mfma_f32_16x16x32_bf16 v[176:179], v[128:131], v[84:87], v[176:179]
    ds_read_b64_tr_b16 v[154:155], v18 offset:30720
    v_mfma_f32_16x16x32_bf16 v[164:167], v[132:135], v[80:83], v[164:167]
    ds_read_b64_tr_b16 v[156:157], v19 offset:28672
    v_mfma_f32_16x16x32_bf16 v[180:183], v[132:135], v[84:87], v[180:183]
    ds_read_b64_tr_b16 v[158:159], v19 offset:30720
    s_waitcnt lgkmcnt(8)
    v_mfma_f32_16x16x32_bf16 v[168:171], v[136:139], v[80:83], v[168:171]
    v_mfma_f32_16x16x32_bf16 v[184:187], v[136:139], v[84:87], v[184:187]
    v_mfma_f32_16x16x32_bf16 v[172:175], v[140:143], v[80:83], v[172:175]
    v_mfma_f32_16x16x32_bf16 v[188:191], v[140:143], v[84:87], v[188:191]
    s_waitcnt vmcnt(0) lgkmcnt(4)
    v_mfma_f32_16x16x32_bf16 v[160:163], v[144:147], v[88:91], v[160:163]
    v_mfma_f32_16x16x32_bf16 v[176:179], v[144:147], v[92:95], v[176:179]
    v_mfma_f32_16x16x32_bf16 v[164:167], v[148:151], v[88:91], v[164:167]
    v_mfma_f32_16x16x32_bf16 v[180:183], v[148:151], v[92:95], v[180:183]
    s_waitcnt lgkmcnt(0)
    v_mfma_f32_16x16x32_bf16 v[168:171], v[152:155], v[88:91], v[168:171]
    v_mfma_f32_16x16x32_bf16 v[184:187], v[152:155], v[92:95], v[184:187]
    v_mfma_f32_16x16x32_bf16 v[172:175], v[156:159], v[88:91], v[172:175]
    v_mfma_f32_16x16x32_bf16 v[188:191], v[156:159], v[92:95], v[188:191]
    s_nop 7
    ds_write_b128 v28, v[176:179] offset:0
    ds_write_b128 v28, v[180:183] offset:1024
    ds_write_b128 v28, v[184:187] offset:2048
    ds_write_b128 v28, v[188:191] offset:3072
    s_waitcnt lgkmcnt(0)
    s_barrier
    ds_read_b128 v[192:195], v29 offset:0
    ds_read_b128 v[196:199], v29 offset:1024
    ds_read_b128 v[200:203], v29 offset:2048
    ds_read_b128 v[204:207], v29 offset:3072
    s_waitcnt lgkmcnt(0)
    v_pk_add_f32 v[192:193], v[160:161], v[192:193]
    v_pk_add_f32 v[194:195], v[162:163], v[194:195]
    v_pk_add_f32 v[196:197], v[164:165], v[196:197]
    v_pk_add_f32 v[198:199], v[166:167], v[198:199]
    v_pk_add_f32 v[200:201], v[168:169], v[200:201]
    v_pk_add_f32 v[202:203], v[170:171], v[202:203]
    v_pk_add_f32 v[204:205], v[172:173], v[204:205]
    v_pk_add_f32 v[206:207], v[174:175], v[206:207]
    v_cvt_pk_bf16_f32 v224, v192, v193
    v_cvt_pk_bf16_f32 v225, v194, v195
    v_cvt_pk_bf16_f32 v226, v196, v197
    v_cvt_pk_bf16_f32 v227, v198, v199
    v_cvt_pk_bf16_f32 v228, v200, v201
    v_cvt_pk_bf16_f32 v229, v202, v203
    v_cvt_pk_bf16_f32 v230, v204, v205
    v_cvt_pk_bf16_f32 v231, v206, v207
    s_nop 1
    v_permlane16_swap_b32 v224, v226
    v_permlane16_swap_b32 v225, v227
    v_permlane16_swap_b32 v228, v230
    v_permlane16_swap_b32 v229, v231
    buffer_store_dwordx4 v[224:227], v27, s[12:15], 0 offen
    buffer_store_dwordx4 v[228:231], v27, s[12:15], 0 offen offset:64
    s_endpgm
L_g_14:
    s_mov_b64 s[74:75], 0
    s_atomic_add_x2 s[74:75], s[36:37], s57 glc
    s_waitcnt lgkmcnt(0)
    s_sub_u32 s42, s42, 1
    s_cbranch_scc0 L_g_14_dc
    s_mov_b32 s42, 0
    s_branch L_g_14_d
L_g_15:
    s_mov_b64 s[74:75], 0
    s_atomic_add_x2 s[74:75], s[36:37], s57 glc
    s_waitcnt lgkmcnt(0)
    s_sub_u32 s42, s42, 1
    s_cbranch_scc0 L_g_15_dc
    s_mov_b32 s42, 0
    s_branch L_g_15_d
L_g_16:
    s_mov_b64 s[74:75], 0
    s_atomic_add_x2 s[74:75], s[36:37], s57 glc
    s_waitcnt lgkmcnt(0)
    s_sub_u32 s42, s42, 1
    s_cbranch_scc0 L_g_16_dc
    s_mov_b32 s42, 0
    s_branch L_g_16_d
L_g_17:
    s_mov_b64 s[74:75], 0
    s_atomic_add_x2 s[74:75], s[36:37], s57 glc
    s_waitcnt lgkmcnt(0)
    s_sub_u32 s42, s42, 1
    s_cbranch_scc0 L_g_17_dc
    s_mov_b32 s42, 0
    s_branch L_g_17_d
L_cs_8:
    ds_read_b64 v[252:253], v7 offset:8
    ds_read_b128 v[176:179], v246 offset:0
    ds_read_b128 v[180:183], v246 offset:64
    ds_read_b128 v[184:187], v246 offset:128
    ds_read_b128 v[188:191], v246 offset:192
    s_waitcnt lgkmcnt(0)
    s_sub_u32 s42, s42, 1
    s_cbranch_scc0 L_cs_8_c
    s_mov_b32 s42, 0
    s_branch L_cs_8_d
.p2align 3
L_pass64b:
    s_waitcnt vmcnt(14) lgkmcnt(8)
    v_mfma_f32_16x16x32_bf16 v[160:163], v[128:131], v[64:67], v[160:163]
    ds_read_b64_tr_b16 v[152:153], v18 offset:4096
    v_mfma_f32_16x16x32_bf16 v[176:179], v[128:131], v[68:71], v[176:179]
    ds_read_b64_tr_b16 v[154:155], v18 offset:6144
    v_mfma_f32_16x16x32_bf16 v[164:167], v[132:135], v[64:67], v[164:167]
    ds_read_b64_tr_b16 v[156:157], v19 offset:4096
    v_mfma_f32_16x16x32_bf16 v[180:183], v[132:135], v[68:71], v[180:183]
    ds_read_b64_tr_b16 v[158:159], v19 offset:6144
    s_waitcnt lgkmcnt(8)
    v_mfma_f32_16x16x32_bf16 v[168:171], v[136:139], v[64:67], v[168:171]
    ds_read_b64_tr_b16 v[128:129], v16 offset:8192
    v_mfma_f32_16x16x32_bf16 v[184:187], v[136:139], v[68:71], v[184:187]
    ds_read_b64_tr_b16 v[130:131], v16 offset:10240
    v_mfma_f32_16x16x32_bf16 v[172:175], v[140:143], v[64:67], v[172:175]
    ds_read_b64_tr_b16 v[132:133], v17 offset:8192
    v_mfma_f32_16x16x32_bf16 v[188:191], v[140:143], v[68:71], v[188:191]
    ds_read_b64_tr_b16 v[134:135], v17 offset:10240
    s_branch L_pass64_c
.p2align 3
L_pass64:
    s_waitcnt vmcnt(14) lgkmcnt(8)
    v_mfma_f32_16x16x32_bf16 v[160:163], v[128:131], v[64:67], 0
    ds_read_b64_tr_b16 v[152:153], v18 offset:4096
    v_mfma_f32_16x16x32_bf16 v[176:179], v[128:131], v[68:71], 0
    ds_read_b64_tr_b16 v[154:155], v18 offset:6144
    v_mfma_f32_16x16x32_bf16 v[164:167], v[132:135], v[64:67], 0
    ds_read_b64_tr_b16 v[156:157], v19 offset:4096
    v_mfma_f32_16x16x32_bf16 v[180:183], v[132:135], v[68:71], 0
    ds_read_b64_tr_b16 v[158:159], v19 offset:6144
    s_waitcnt lgkmcnt(8)
    v_mfma_f32_16x16x32_bf16 v[168:171], v[136:139], v[64:67], 0
    ds_read_b64_tr_b16 v[128:129], v16 offset:8192
    v_mfma_f32_16x16x32_bf16 v[184:187], v[136:139], v[68:71], 0
    ds_read_b64_tr_b16 v[130:131], v16 offset:10240
    v_mfma_f32_16x16x32_bf16 v[172:175], v[140:143], v[64:67], 0
    ds_read_b64_tr_b16 v[132:133], v17 offset:8192
    v_mfma_f32_16x16x32_bf16 v[188:191], v[140:143], v[68:71], 0
    ds_read_b64_tr_b16 v[134:135], v17 offset:10240
L_pass64_c:
    s_waitcnt vmcnt(12) lgkmcnt(8)
    v_mfma_f32_16x16x32_bf16 v[160:163], v[144:147], v[72:75], v[160:163]
    ds_read_b64_tr_b16 v[136:137], v18 offset:8192
    v_mfma_f32_16x16x32_bf16 v[176:179], v[144:147], v[76:79], v[176:179]
    ds_read_b64_tr_b16 v[138:139], v18 offset:10240
    v_mfma_f32_16x16x32_bf16 v[164:167], v[148:151], v[72:75], v[164:167]
    ds_read_b64_tr_b16 v[140:141], v19 offset:8192
    v_mfma_f32_16x16x32_bf16 v[180:183], v[148:151], v[76:79], v[180:183]
    ds_read_b64_tr_b16 v[142:143], v19 offset:10240
    s_waitcnt lgkmcnt(8)
    v_mfma_f32_16x16x32_bf16 v[168:171], v[152:155], v[72:75], v[168:171]
    ds_read_b64_tr_b16 v[144:145], v16 offset:12288
    v_mfma_f32_16x16x32_bf16 v[184:187], v[152:155], v[76:79], v[184:187]
    ds_read_b64_tr_b16 v[146:147], v16 offset:14336
    v_mfma_f32_16x16x32_bf16 v[172:175], v[156:159], v[72:75], v[172:175]
    ds_read_b64_tr_b16 v[148:149], v17 offset:12288
    v_mfma_f32_16x16x32_bf16 v[188:191], v[156:159], v[76:79], v[188:191]
    ds_read_b64_tr_b16 v[150:151], v17 offset:14336
    s_waitcnt vmcnt(10) lgkmcnt(8)
    v_mfma_f32_16x16x32_bf16 v[160:163], v[128:131], v[80:83], v[160:163]
    ds_read_b64_tr_b16 v[152:153], v18 offset:12288
    v_mfma_f32_16x16x32_bf16 v[176:179], v[128:131], v[84:87], v[176:179]
    ds_read_b64_tr_b16 v[154:155], v18 offset:14336
    v_mfma_f32_16x16x32_bf16 v[164:167], v[132:135], v[80:83], v[164:167]
    ds_read_b64_tr_b16 v[156:157], v19 offset:12288
    v_mfma_f32_16x16x32_bf16 v[180:183], v[132:135], v[84:87], v[180:183]
    ds_read_b64_tr_b16 v[158:159], v19 offset:14336
    s_waitcnt lgkmcnt(8)
    v_mfma_f32_16x16x32_bf16 v[168:171], v[136:139], v[80:83], v[168:171]
    ds_read_b64_tr_b16 v[192:193], v16 offset:16384
    ds_read_b64_tr_b16 v[194:195], v16 offset:18432
    v_mfma_f32_16x16x32_bf16 v[184:187], v[136:139], v[84:87], v[184:187]
    ds_read_b64_tr_b16 v[196:197], v17 offset:16384
    v_mfma_f32_16x16x32_bf16 v[172:175], v[140:143], v[80:83], v[172:175]
    ds_read_b64_tr_b16 v[198:199], v17 offset:18432
    ds_read_b64_tr_b16 v[200:201], v18 offset:16384
    v_mfma_f32_16x16x32_bf16 v[188:191], v[140:143], v[84:87], v[188:191]
    ds_read_b64_tr_b16 v[202:203], v18 offset:18432
    s_waitcnt vmcnt(8) lgkmcnt(10)
    v_mfma_f32_16x16x32_bf16 v[160:163], v[144:147], v[88:91], v[160:163]
    ds_read_b64_tr_b16 v[204:205], v19 offset:16384
    ds_read_b64_tr_b16 v[206:207], v19 offset:18432
    v_mfma_f32_16x16x32_bf16 v[176:179], v[144:147], v[92:95], v[176:179]
    ds_read_b64_tr_b16 v[208:209], v16 offset:20480
    v_mfma_f32_16x16x32_bf16 v[164:167], v[148:151], v[88:91], v[164:167]
    ds_read_b64_tr_b16 v[210:211], v16 offset:22528
    ds_read_b64_tr_b16 v[212:213], v17 offset:20480
    v_mfma_f32_16x16x32_bf16 v[180:183], v[148:151], v[92:95], v[180:183]
    ds_read_b64_tr_b16 v[214:215], v17 offset:22528
    s_waitcnt lgkmcnt(12)
    v_mfma_f32_16x16x32_bf16 v[168:171], v[152:155], v[88:91], v[168:171]
    ds_read_b64_tr_b16 v[216:217], v18 offset:20480
    ds_read_b64_tr_b16 v[218:219], v18 offset:22528
    v_mfma_f32_16x16x32_bf16 v[184:187], v[152:155], v[92:95], v[184:187]
    ds_read_b64_tr_b16 v[220:221], v19 offset:20480
    v_mfma_f32_16x16x32_bf16 v[172:175], v[156:159], v[88:91], v[172:175]
    ds_read_b64_tr_b16 v[222:223], v19 offset:22528
    ds_read_b64_tr_b16 v[128:129], v16 offset:24576
    v_mfma_f32_16x16x32_bf16 v[188:191], v[156:159], v[92:95], v[188:191]
    ds_read_b64_tr_b16 v[130:131], v16 offset:26624
    s_waitcnt vmcnt(6) lgkmcnt(14)
    v_mfma_f32_16x16x32_bf16 v[176:179], v[192:195], v[100:103], v[176:179]
    ds_read_b64_tr_b16 v[132:133], v17 offset:24576
    ds_read_b64_tr_b16 v[134:135], v17 offset:26624
    v_mfma_f32_16x16x32_bf16 v[180:183], v[196:199], v[100:103], v[180:183]
    ds_read_b64_tr_b16 v[136:137], v18 offset:24576
    ds_read_b64_tr_b16 v[138:139], v18 offset:26624
    s_waitcnt lgkmcnt(14)
    v_mfma_f32_16x16x32_bf16 v[184:187], v[200:203], v[100:103], v[184:187]
    ds_read_b64_tr_b16 v[140:141], v19 offset:24576
    ds_read_b64_tr_b16 v[142:143], v19 offset:26624
    v_mfma_f32_16x16x32_bf16 v[188:191], v[204:207], v[100:103], v[188:191]
    ds_read_b64_tr_b16 v[144:145], v16 offset:28672
    ds_read_b64_tr_b16 v[146:147], v16 offset:30720
    s_waitcnt vmcnt(4) lgkmcnt(14)
    v_mfma_f32_16x16x32_bf16 v[176:179], v[208:211], v[108:111], v[176:179]
    ds_read_b64_tr_b16 v[148:149], v17 offset:28672
    ds_read_b64_tr_b16 v[150:151], v17 offset:30720
    v_mfma_f32_16x16x32_bf16 v[180:183], v[212:215], v[108:111], v[180:183]
    ds_read_b64_tr_b16 v[152:153], v18 offset:28672
    ds_read_b64_tr_b16 v[154:155], v18 offset:30720
    s_waitcnt lgkmcnt(14)
    v_mfma_f32_16x16x32_bf16 v[184:187], v[216:219], v[108:111], v[184:187]
    ds_read_b64_tr_b16 v[156:157], v19 offset:28672
    ds_read_b64_tr_b16 v[158:159], v19 offset:30720
    v_mfma_f32_16x16x32_bf16 v[188:191], v[220:223], v[108:111], v[188:191]
    v_xor_b32 v16, 0x8000, v16
    s_waitcnt vmcnt(2) lgkmcnt(12)
    v_mfma_f32_16x16x32_bf16 v[176:179], v[128:131], v[116:119], v[176:179]
    v_xor_b32 v17, 0x8000, v17
    v_mfma_f32_16x16x32_bf16 v[180:183], v[132:135], v[116:119], v[180:183]
    v_xor_b32 v18, 0x8000, v18
    s_waitcnt lgkmcnt(8)
    v_mfma_f32_16x16x32_bf16 v[184:187], v[136:139], v[116:119], v[184:187]
    v_xor_b32 v19, 0x8000, v19
    v_mfma_f32_16x16x32_bf16 v[188:191], v[140:143], v[116:119], v[188:191]
    s_waitcnt vmcnt(0) lgkmcnt(4)
    v_mfma_f32_16x16x32_bf16 v[176:179], v[144:147], v[124:127], v[176:179]
    s_cbranch_vccnz L_pubhook
L_pubret:
    v_mfma_f32_16x16x32_bf16 v[180:183], v[148:151], v[124:127], v[180:183]
    s_waitcnt lgkmcnt(0)
    v_mfma_f32_16x16x32_bf16 v[184:187], v[152:155], v[124:127], v[184:187]
    v_mfma_f32_16x16x32_bf16 v[188:191], v[156:159], v[124:127], v[188:191]
    s_bitcmp1_b32 s89, 0
    s_cbranch_scc1 L_pass64_f
    v_mfma_f32_16x16x32_bf16 v[160:163], v[192:195], v[96:99], v[160:163]
    v_mfma_f32_16x16x32_bf16 v[164:167], v[196:199], v[96:99], v[164:167]
    v_mfma_f32_16x16x32_bf16 v[168:171], v[200:203], v[96:99], v[168:171]
    v_mfma_f32_16x16x32_bf16 v[172:175], v[204:207], v[96:99], v[172:175]
    ds_write_b128 v28, v[176:179] offset:0
    v_mfma_f32_16x16x32_bf16 v[160:163], v[208:211], v[104:107], v[160:163]
    v_mfma_f32_16x16x32_bf16 v[164:167], v[212:215], v[104:107], v[164:167]
    ds_write_b128 v28, v[180:183] offset:1024
    v_mfma_f32_16x16x32_bf16 v[168:171], v[216:219], v[104:107], v[168:171]
    v_mfma_f32_16x16x32_bf16 v[172:175], v[220:223], v[104:107], v[172:175]
    ds_write_b128 v28, v[184:187] offset:2048
    v_mfma_f32_16x16x32_bf16 v[160:163], v[128:131], v[112:115], v[160:163]
    v_mfma_f32_16x16x32_bf16 v[164:167], v[132:135], v[112:115], v[164:167]
    ds_write_b128 v28, v[188:191] offset:3072
    v_mfma_f32_16x16x32_bf16 v[168:171], v[136:139], v[112:115], v[168:171]
    v_mfma_f32_16x16x32_bf16 v[172:175], v[140:143], v[112:115], v[172:175]
    s_waitcnt lgkmcnt(0)
    s_barrier
    v_mfma_f32_16x16x32_bf16 v[160:163], v[144:147], v[120:123], v[160:163]
    ds_read_b128 v[192:195], v29 offset:0
    ds_read_b128 v[196:199], v29 offset:1024
    v_mfma_f32_16x16x32_bf16 v[164:167], v[148:151], v[120:123], v[164:167]
    ds_read_b128 v[200:203], v29 offset:2048
    ds_read_b128 v[204:207], v29 offset:3072
    v_mfma_f32_16x16x32_bf16 v[168:171], v[152:155], v[120:123], v[168:171]
    ds_read_b64_tr_b16 v[128:129], v16 offset:0
    ds_read_b64_tr_b16 v[130:131], v16 offset:2048
    v_mfma_f32_16x16x32_bf16 v[172:175], v[156:159], v[120:123], v[172:175]
    ds_read_b64_tr_b16 v[132:133], v17 offset:0
    ds_read_b64_tr_b16 v[134:135], v17 offset:2048
    ds_read_b128 v[176:179], v246 offset:0
    ds_read_b128 v[180:183], v246 offset:64
    ds_read_b128 v[184:187], v246 offset:128
    ds_read_b128 v[188:191], v246 offset:192
    ds_read_b64_tr_b16 v[136:137], v18 offset:0
    ds_read_b64_tr_b16 v[138:139], v18 offset:2048
    ds_read_b64_tr_b16 v[140:141], v19 offset:0
    ds_read_b64_tr_b16 v[142:143], v19 offset:2048
    ds_read_b64_tr_b16 v[144:145], v16 offset:4096
    ds_read_b64_tr_b16 v[146:147], v16 offset:6144
    ds_read_b64_tr_b16 v[148:149], v17 offset:4096
    ds_read_b64_tr_b16 v[150:151], v17 offset:6144
    s_waitcnt lgkmcnt(15)
    v_pk_add_f32 v[192:193], v[160:161], v[192:193]
    v_pk_add_f32 v[194:195], v[162:163], v[194:195]
    v_pk_add_f32 v[196:197], v[164:165], v[196:197]
    v_pk_add_f32 v[198:199], v[166:167], v[198:199]
    v_pk_add_f32 v[200:201], v[168:169], v[200:201]
    v_pk_add_f32 v[202:203], v[170:171], v[202:203]
    v_pk_add_f32 v[204:205], v[172:173], v[204:205]
    v_pk_add_f32 v[206:207], v[174:175], v[206:207]
    s_waitcnt lgkmcnt(8)
    s_setpc_b64 s[48:49]
.p2align 3
L_pass64_f:
    v_mfma_f32_16x16x32_bf16 v[160:163], v[192:195], v[96:99], v[160:163]
    s_add_u32 s90, s90, 1
    v_mfma_f32_16x16x32_bf16 v[164:167], v[196:199], v[96:99], v[164:167]
    v_mov_b32 v9, s90
    v_mfma_f32_16x16x32_bf16 v[168:171], v[200:203], v[96:99], v[168:171]
    ds_write_b128 v28, v[176:179] offset:0
    v_mfma_f32_16x16x32_bf16 v[172:175], v[204:207], v[96:99], v[172:175]
    v_mfma_f32_16x16x32_bf16 v[160:163], v[208:211], v[104:107], v[160:163]
    ds_write_b128 v28, v[180:183] offset:1024
    v_mfma_f32_16x16x32_bf16 v[164:167], v[212:215], v[104:107], v[164:167]
    v_mfma_f32_16x16x32_bf16 v[168:171], v[216:219], v[104:107], v[168:171]
    ds_write_b128 v28, v[184:187] offset:2048
    v_mfma_f32_16x16x32_bf16 v[172:175], v[220:223], v[104:107], v[172:175]
    v_mfma_f32_16x16x32_bf16 v[160:163], v[128:131], v[112:115], v[160:163]
    ds_write_b128 v28, v[188:191] offset:3072
    v_mfma_f32_16x16x32_bf16 v[164:167], v[132:135], v[112:115], v[164:167]
    s_waitcnt lgkmcnt(0)
    ds_write_b32 v248, v9 offset:16
    ds_read_b64 v[252:253], v7 offset:8
    v_mfma_f32_16x16x32_bf16 v[168:171], v[136:139], v[112:115], v[168:171]
    ds_read_b128 v[176:179], v246 offset:0
    ds_read_b128 v[180:183], v246 offset:64
    v_mfma_f32_16x16x32_bf16 v[172:175], v[140:143], v[112:115], v[172:175]
    ds_read_b128 v[184:187], v246 offset:128
    ds_read_b128 v[188:191], v246 offset:192
    v_mfma_f32_16x16x32_bf16 v[160:163], v[144:147], v[120:123], v[160:163]
    v_mfma_f32_16x16x32_bf16 v[164:167], v[148:151], v[120:123], v[164:167]
    ds_read_b32 v8, v249 offset:16
    ds_read_b128 v[192:195], v29 offset:0
    v_mfma_f32_16x16x32_bf16 v[168:171], v[152:155], v[120:123], v[168:171]
    ds_read_b128 v[196:199], v29 offset:1024
    ds_read_b128 v[200:203], v29 offset:2048
    v_mfma_f32_16x16x32_bf16 v[172:175], v[156:159], v[120:123], v[172:175]
    ds_read_b128 v[204:207], v29 offset:3072
    s_nop 1
L_xf_w:
    s_waitcnt lgkmcnt(0)
    v_readfirstlane_b32 s44, v8
    v_pk_add_f32 v[192:193], v[160:161], v[192:193]
    v_pk_add_f32 v[194:195], v[162:163], v[194:195]
    v_pk_add_f32 v[196:197], v[164:165], v[196:197]
    v_pk_add_f32 v[198:199], v[166:167], v[198:199]
    v_pk_add_f32 v[200:201], v[168:169], v[200:201]
    v_pk_add_f32 v[202:203], v[170:171], v[202:203]
    v_pk_add_f32 v[204:205], v[172:173], v[204:205]
    v_pk_add_f32 v[206:207], v[174:175], v[206:207]
    s_cmp_ge_u32 s44, s90
    s_cbranch_scc0 L_xf_r
L_xf_d:
    s_setpc_b64 s[48:49]
L_xf_r:
    ds_read_b32 v8, v249 offset:16
    ds_read_b128 v[192:195], v29 offset:0
    ds_read_b128 v[196:199], v29 offset:1024
    ds_read_b128 v[200:203], v29 offset:2048
    ds_read_b128 v[204:207], v29 offset:3072
    s_sub_u32 s42, s42, 1
    s_cbranch_scc0 L_xf_w
    s_mov_b32 s42, 0
    s_branch L_xf_d
L_pubhook:
    v_mov_b32 v8, s55
    s_waitcnt vmcnt(0)
    buffer_atomic_add v8, v11, s[8:11], s54 offen sc1
    s_mov_b64 vcc, 0
    s_branch L_pubret
.p2align 3
L_gelu:
    v_pk_mul_f32 v[192:193], v[192:193], v[22:23]
    v_pk_mul_f32 v[194:195], v[194:195], v[22:23]
    v_pk_mul_f32 v[196:197], v[196:197], v[22:23]
    v_pk_mul_f32 v[198:199], v[198:199], v[22:23]
    v_pk_fma_f32 v[192:193], v[176:177], v[240:241], v[192:193]
    v_pk_fma_f32 v[194:195], v[178:179], v[240:241], v[194:195]
    v_pk_fma_f32 v[196:197], v[180:181], v[240:241], v[196:197]
    v_pk_fma_f32 v[198:199], v[182:183], v[240:241], v[198:199]
    v_pk_mul_f32 v[208:209], v[192:193], v[192:193]
    v_pk_mul_f32 v[210:211], v[194:195], v[194:195]
    v_pk_mul_f32 v[212:213], v[196:197], v[196:197]
    v_pk_mul_f32 v[214:215], v[198:199], v[198:199]
    v_pk_fma_f32 v[208:209], v[208:209], v[242:243], v[30:31]
    v_pk_fma_f32 v[210:211], v[210:211], v[242:243], v[30:31]
    v_pk_fma_f32 v[212:213], v[212:213], v[242:243], v[30:31]
    v_pk_fma_f32 v[214:215], v[214:215], v[242:243], v[30:31]
    v_pk_mul_f32 v[208:209], v[208:209], v[192:193]
    v_pk_mul_f32 v[210:211], v[210:211], v[194:195]
    v_pk_mul_f32 v[212:213], v[212:213], v[196:197]
    v_pk_mul_f32 v[214:215], v[214:215], v[198:199]
    v_exp_f32 v208, v208
    v_exp_f32 v209, v209
    v_exp_f32 v210, v210
    v_exp_f32 v211, v211
    v_exp_f32 v212, v212
    v_exp_f32 v213, v213
    v_exp_f32 v214, v214
    v_exp_f32 v215, v215
    v_pk_add_f32 v[208:209], v[208:209], s[76:77]
    v_pk_add_f32 v[210:211], v[210:211], s[76:77]
    v_pk_add_f32 v[212:213], v[212:213], s[76:77]
    v_pk_add_f32 v[214:215], v[214:215], s[76:77]
    v_rcp_f32 v208, v208
    v_rcp_f32 v209, v209
    v_rcp_f32 v210, v210
    v_rcp_f32 v211, v211
    v_rcp_f32 v212, v212
    v_rcp_f32 v213, v213
    v_rcp_f32 v214, v214
    v_rcp_f32 v215, v215
    v_pk_mul_f32 v[192:193], v[192:193], v[208:209]
    v_pk_mul_f32 v[194:195], v[194:195], v[210:211]
    v_pk_mul_f32 v[196:197], v[196:197], v[212:213]
    v_pk_mul_f32 v[198:199], v[198:199], v[214:215]
    v_cvt_pk_bf16_f32 v224, v192, v193
    v_cvt_pk_bf16_f32 v225, v194, v195
    v_cvt_pk_bf16_f32 v226, v196, v197
    v_cvt_pk_bf16_f32 v227, v198, v199
    s_cmp_eq_u32 s43, 1
    s_cbranch_scc1 L_gelu_h
    v_pk_mul_f32 v[200:201], v[200:201], v[22:23]
    v_pk_mul_f32 v[202:203], v[202:203], v[22:23]
    v_pk_mul_f32 v[204:205], v[204:205], v[22:23]
    v_pk_mul_f32 v[206:207], v[206:207], v[22:23]
    v_pk_fma_f32 v[200:201], v[184:185], v[240:241], v[200:201]
    v_pk_fma_f32 v[202:203], v[186:187], v[240:241], v[202:203]
    v_pk_fma_f32 v[204:205], v[188:189], v[240:241], v[204:205]
    v_pk_fma_f32 v[206:207], v[190:191], v[240:241], v[206:207]
    v_pk_mul_f32 v[208:209], v[200:201], v[200:201]
    v_pk_mul_f32 v[210:211], v[202:203], v[202:203]
    v_pk_mul_f32 v[212:213], v[204:205], v[204:205]
    v_pk_mul_f32 v[214:215], v[206:207], v[206:207]
    v_pk_fma_f32 v[208:209], v[208:209], v[242:243], v[30:31]
    v_pk_fma_f32 v[210:211], v[210:211], v[242:243], v[30:31]
    v_pk_fma_f32 v[212:213], v[212:213], v[242:243], v[30:31]
    v_pk_fma_f32 v[214:215], v[214:215], v[242:243], v[30:31]
    v_pk_mul_f32 v[208:209], v[208:209], v[200:201]
    v_pk_mul_f32 v[210:211], v[210:211], v[202:203]
    v_pk_mul_f32 v[212:213], v[212:213], v[204:205]
    v_pk_mul_f32 v[214:215], v[214:215], v[206:207]
    v_exp_f32 v208, v208
    v_exp_f32 v209, v209
    v_exp_f32 v210, v210
    v_exp_f32 v211, v211
    v_exp_f32 v212, v212
    v_exp_f32 v213, v213
    v_exp_f32 v214, v214
    v_exp_f32 v215, v215
    v_pk_add_f32 v[208:209], v[208:209], s[76:77]
    v_pk_add_f32 v[210:211], v[210:211], s[76:77]
    v_pk_add_f32 v[212:213], v[212:213], s[76:77]
    v_pk_add_f32 v[214:215], v[214:215], s[76:77]
    v_rcp_f32 v208, v208
    v_rcp_f32 v209, v209
    v_rcp_f32 v210, v210
    v_rcp_f32 v211, v211
    v_rcp_f32 v212, v212
    v_rcp_f32 v213, v213
    v_rcp_f32 v214, v214
    v_rcp_f32 v215, v215
    v_pk_mul_f32 v[200:201], v[200:201], v[208:209]
    v_pk_mul_f32 v[202:203], v[202:203], v[210:211]
    v_pk_mul_f32 v[204:205], v[204:205], v[212:213]
    v_pk_mul_f32 v[206:207], v[206:207], v[214:215]
    v_cvt_pk_bf16_f32 v228, v200, v201
    v_cvt_pk_bf16_f32 v229, v202, v203
    v_cvt_pk_bf16_f32 v230, v204, v205
    v_cvt_pk_bf16_f32 v231, v206, v207
L_gelu_h:
    s_setpc_b64 s[50:51]
L_service:
    v_lshrrev_b32 v3, 2, v0
    v_and_b32 v4, 3, v0
    v_lshlrev_b32 v5, 7, v4
    v_lshl_add_u32 v37, v3, 10, v5
    v_mul_u32_u24 v39, 3072, v3
    v_add_u32 v39, v39, v5
    v_min_u32 v3, 13, v2
    v_lshlrev_b32 v3, 7, v3
    v_mul_u32_u24 v38, 3584, v1
    v_add_u32 v38, v38, v3
    s_lshl_b32 s44, s65, 9
    s_lshl_b32 s85, s64, 14
    s_add_u32 s85, s85, s44
    s_mul_i32 s87, s64, 49152
    s_add_u32 s87, s87, s44
    s_mul_i32 s86, s64, 14336
    s_mul_i32 s44, s65, 1792
    s_add_u32 s86, s86, s44
    s_cmp_ge_u32 s3, 6
    s_cbranch_scc1 L_loader
L_helper:
    v_lshrrev_b32 v4, 2, v0
    v_bfe_u32 v5, v4, 1, 2
    v_lshlrev_b32 v5, 5, v5
    v_and_b32 v3, 3, v0
    v_lshl_add_u32 v5, v3, 3, v5
    v_lshl_add_u32 v12, v4, 7, v5
    v_xor_b32 v13, 32, v12
    v_xor_b32 v14, 64, v12
    v_xor_b32 v15, 96, v12
    v_and_b32 v5, 1, v1
    v_lshlrev_b32 v5, 5, v5
    v_lshl_add_u32 v5, v3, 3, v5
    v_lshl_add_u32 v20, v4, 6, v5
    v_xor_b32 v21, 32, v20
    s_lshl_b32 s44, s67, 6
    v_xor_b32 v12, s44, v12
    v_xor_b32 v13, s44, v13
    s_lshl_b32 s45, s67, 5
    v_xor_b32 v20, s45, v20
    v_lshlrev_b32 v3, 4, v1
    v_add_u32 v36, 162816, v3
    s_mov_b32 s70, 0x00010001
    s_mov_b32 s71, 0x00010001
    v_mov_b32 v40, s52
    v_mov_b32 v41, s52
    v_mov_b32 v42, s52
    v_mov_b32 v43, s52
    s_waitcnt lgkmcnt(0)
    s_mov_b32 s8, s36
    s_mov_b32 s9, s37
    s_barrier
    s_lshl_b32 s44, s38, 3
    s_add_u32 s44, s44, s3
    s_cmp_lg_u32 s44, 4
    s_cbranch_scc1 L_nozero
    v_mov_b32 v64, 0
    v_mov_b32 v65, 0
    v_mov_b32 v66, 0
    v_mov_b32 v67, 0
    s_lshl_b32 s44, s39, 8
    s_lshl_b32 s45, s39, 10
    s_add_u32 s45, s45, 7936
    v_mov_b32 v4, s44
    v_mov_b32 v5, s45
    v_cmp_gt_u32 s[68:69], 2, v0
    s_mov_b32 s44, 15990784
    s_nop 0
    v_cndmask_b32 v4, v5, v4, s[68:69]
    v_lshl_add_u32 v4, v0, 7, v4
    s_mov_b64 exec, 0x3ff
    buffer_store_dwordx4 v[64:67], v4, s[8:11], s44 offen sc1
    s_lshl_b32 s44, s39, 2
    v_mov_b32 v3, s44
    v_mov_b32 v8, 1
    s_mov_b64 exec, 1
    s_waitcnt vmcnt(0)
    global_store_dword v3, v8, s[34:35] offset:128 sc1
    s_mov_b64 exec, -1
L_nozero:
    v_mov_b32 v8, 0
    v_min_u32 v3, 15, v0
    v_lshl_add_u32 v3, v3, 2, v7
    ds_write_b32 v3, v8
    s_waitcnt lgkmcnt(0)
    s_barrier
    v_min_u32 v3, 2, v0
    s_sub_u32 s44, s39, 1
    v_add_u32 v3, s44, v3
    v_max_i32 v3, 0, v3
    v_min_u32 v3, 31, v3
    v_lshlrev_b32 v44, 2, v3
    s_barrier
    s_cmp_eq_u32 s3, 4
    s_cbranch_scc1 L_in_n
    s_sleep 1
    global_load_dword v45, v44, s[34:35] offset:128
L_in_n:
    s_barrier
    s_cmp_eq_u32 s3, 4
    s_cbranch_scc1 L_in_d
    s_branch L_in_chk
L_in_loop:
    s_sleep 8
    global_load_dword v45, v44, s[34:35] offset:128 sc1
L_in_chk:
    s_waitcnt vmcnt(0)
    v_cmp_eq_u32 s[68:69], 1, v45
    s_cmp_eq_u64 s[68:69], -1
    s_cbranch_scc0 L_in_loop_s
L_in_d:
    s_barrier
    s_barrier
    s_barrier
    s_cmp_lg_u32 s3, 5
    s_cbranch_scc1 L_hf_18a
    s_lshl_b32 s44, s39, 3
    s_add_u32 s44, s44, s38
    s_sub_u32 s44, s44, 8
    s_lshl_b32 s66, s44, 12
    s_add_u32 s66, s66, 16777216
    s_lshl_b32 s44, s44, 7
    s_add_u32 s44, s44, 15998976
    s_cmp_eq_u32 s39, 0
    s_cselect_b32 s66, 1073741824, s66
    s_cbranch_scc1 L_hf_18_d
L_hf_18_l:
    s_mov_b32 s68, 0
    s_atomic_add s68, s[36:37], s44 glc
    s_waitcnt lgkmcnt(0)
    s_bitcmp1_b32 s68, 0
    s_cbranch_scc0 L_hf_18_l_s
L_hf_18_d:
    buffer_load_dwordx4 v[64:67], v10, s[8:11], s66 offen sc1
    buffer_load_dwordx4 v[68:71], v10, s[8:11], s66 offen offset:1024 sc1
L_hf_18a:
    s_barrier
    s_cmp_lg_u32 s3, 5
    s_cbranch_scc1 L_hf_18
    v_lshlrev_b32 v3, 7, v2
    v_lshl_add_u32 v3, v1, 5, v3
    v_cmp_lt_u32 s[68:69], 1, v2
    v_add_u32 v3, 147200, v3
    v_mov_b32 v5, 196608
    v_cndmask_b32 v3, v5, v3, s[68:69]
    v_mov_b32 v8, 1
    s_waitcnt vmcnt(0)
    ds_write_b128 v3, v[64:67]
    ds_write_b128 v3, v[68:71] offset:16
    s_waitcnt lgkmcnt(0)
    ds_write_b32 v7, v8 offset:0
L_hf_18:
    s_cmp_lg_u32 s3, 5
    s_cbranch_scc1 L_hf_19a
    s_lshl_b32 s44, s39, 3
    s_add_u32 s44, s44, s38
    s_sub_u32 s44, s44, 8
    s_lshl_b32 s66, s44, 12
    s_add_u32 s66, s66, 16779264
    s_lshl_b32 s44, s44, 7
    s_add_u32 s44, s44, 15998976
    s_cmp_eq_u32 s39, 0
    s_cselect_b32 s66, 1073741824, s66
    s_cbranch_scc1 L_hf_19_d
L_hf_19_l:
    s_mov_b32 s68, 0
    s_atomic_add s68, s[36:37], s44 glc
    s_waitcnt lgkmcnt(0)
    s_bitcmp1_b32 s68, 8
    s_cbranch_scc0 L_hf_19_l_s
L_hf_19_d:
    buffer_load_dwordx4 v[64:67], v10, s[8:11], s66 offen sc1
    buffer_load_dwordx4 v[68:71], v10, s[8:11], s66 offen offset:1024 sc1
L_hf_19a:
    s_cmp_lg_u32 s3, 5
    s_cbranch_scc1 L_hf_19
    v_bfe_u32 v3, v2, 1, 2
    v_lshlrev_b32 v3, 1, v3
    v_lshrrev_b32 v4, 1, v1
    v_xor_b32 v3, v3, v4
    v_lshlrev_b32 v3, 4, v3
    v_lshl_add_u32 v3, v2, 7, v3
    v_and_b32 v4, 1, v1
    v_lshl_add_u32 v3, v4, 3, v3
    v_add_u32 v72, 131072, v3
    v_xor_b32 v73, 32, v72
    v_xor_b32 v74, 64, v72
    v_xor_b32 v75, 96, v72
L_ak_20:
    ds_read_b32 v9, v7 offset:36
    s_waitcnt lgkmcnt(0)
    v_readfirstlane_b32 s44, v9
    s_cmp_lg_u32 s44, 0
    s_cbranch_scc0 L_ak_20_s
L_ak_20_d:
    v_mov_b32 v8, 2
    s_waitcnt vmcnt(0)
    ds_write_b64 v72, v[64:65]
    ds_write_b64 v73, v[66:67]
    ds_write_b64 v74, v[68:69]
    ds_write_b64 v75, v[70:71]
    s_waitcnt lgkmcnt(0)
    ds_write_b32 v7, v8 offset:0
L_hf_19:
    s_barrier
    s_barrier
    s_mov_b32 s44, 0
    s_call_b64 s[48:49], L_cs
    s_lshl_b32 s44, s67, 7
    v_add_u32 v3, s44, v36
    s_mov_b64 exec, s[70:71]
    ds_write_b128 v3, v[160:163] offset:0
    ds_write_b128 v3, v[164:167] offset:64
    s_mov_b64 exec, -1
    s_waitcnt lgkmcnt(0)
    s_lshl_b32 s44, s67, 2
    v_add_u32 v3, s44, v7
    v_mov_b32 v8, 1
    ds_write_b32 v3, v8 offset:8
    s_barrier
    s_barrier
    s_mov_b32 s44, 0
    s_call_b64 s[48:49], L_cs
    s_lshl_b32 s44, s67, 7
    v_add_u32 v3, s44, v36
    s_mov_b64 exec, s[70:71]
    ds_write_b128 v3, v[160:163] offset:256
    ds_write_b128 v3, v[164:167] offset:320
    s_mov_b64 exec, -1
    s_waitcnt lgkmcnt(0)
    s_barrier
    s_mov_b32 s44, 32768
    s_call_b64 s[48:49], L_cs
    s_lshl_b32 s44, s67, 7
    v_add_u32 v3, s44, v36
    s_mov_b64 exec, s[70:71]
    ds_write_b128 v3, v[160:163] offset:512
    ds_write_b128 v3, v[164:167] offset:576
    s_mov_b64 exec, -1
    s_waitcnt lgkmcnt(0)
    s_barrier
    s_mov_b32 s44, 0
    s_call_b64 s[48:49], L_cs
    s_lshl_b32 s44, s67, 7
    v_add_u32 v3, s44, v36
    s_mov_b64 exec, s[70:71]
    ds_write_b128 v3, v[160:163] offset:256
    ds_write_b128 v3, v[164:167] offset:320
    s_mov_b64 exec, -1
    s_waitcnt lgkmcnt(0)
    s_barrier
    s_mov_b32 s44, 32768
    s_call_b64 s[48:49], L_csh
    s_lshl_b32 s44, s67, 6
    v_add_u32 v3, s44, v36
    s_mov_b64 exec, s[70:71]
    ds_write_b128 v3, v[160:163] offset:512
    s_mov_b64 exec, -1
    s_waitcnt lgkmcnt(0)
    s_endpgm
L_cs:
    v_add_u32 v16, s44, v12
    v_add_u32 v17, s44, v13
    s_add_u32 s44, s44, 65536
    ds_read_b64_tr_b16 v[64:65], v16 offset:0
    ds_read_b64_tr_b16 v[66:67], v16 offset:2048
    ds_read_b64_tr_b16 v[68:69], v17 offset:0
    ds_read_b64_tr_b16 v[70:71], v17 offset:2048
    ds_read_b64_tr_b16 v[72:73], v16 offset:4096
    ds_read_b64_tr_b16 v[74:75], v16 offset:6144
    ds_read_b64_tr_b16 v[76:77], v17 offset:4096
    ds_read_b64_tr_b16 v[78:79], v17 offset:6144
    ds_read_b64_tr_b16 v[80:81], v16 offset:8192
    ds_read_b64_tr_b16 v[82:83], v16 offset:10240
    ds_read_b64_tr_b16 v[84:85], v17 offset:8192
    ds_read_b64_tr_b16 v[86:87], v17 offset:10240
    ds_read_b64_tr_b16 v[88:89], v16 offset:12288
    ds_read_b64_tr_b16 v[90:91], v16 offset:14336
    ds_read_b64_tr_b16 v[92:93], v17 offset:12288
    ds_read_b64_tr_b16 v[94:95], v17 offset:14336
    s_waitcnt lgkmcnt(14)
    v_mfma_f32_16x16x32_bf16 v[160:163], v[64:67], v[40:43], 0
    s_waitcnt lgkmcnt(12)
    v_mfma_f32_16x16x32_bf16 v[164:167], v[68:71], v[40:43], 0
    s_waitcnt lgkmcnt(10)
    v_mfma_f32_16x16x32_bf16 v[160:163], v[72:75], v[40:43], v[160:163]
    s_waitcnt lgkmcnt(8)
    v_mfma_f32_16x16x32_bf16 v[164:167], v[76:79], v[40:43], v[164:167]
    s_waitcnt lgkmcnt(6)
    v_mfma_f32_16x16x32_bf16 v[160:163], v[80:83], v[40:43], v[160:163]
    s_waitcnt lgkmcnt(4)
    v_mfma_f32_16x16x32_bf16 v[164:167], v[84:87], v[40:43], v[164:167]
    s_waitcnt lgkmcnt(2)
    v_mfma_f32_16x16x32_bf16 v[160:163], v[88:91], v[40:43], v[160:163]
    s_waitcnt lgkmcnt(0)
    v_mfma_f32_16x16x32_bf16 v[164:167], v[92:95], v[40:43], v[164:167]
    ds_read_b64_tr_b16 v[64:65], v16 offset:16384
    ds_read_b64_tr_b16 v[66:67], v16 offset:18432
    ds_read_b64_tr_b16 v[68:69], v17 offset:16384
    ds_read_b64_tr_b16 v[70:71], v17 offset:18432
    ds_read_b64_tr_b16 v[72:73], v16 offset:20480
    ds_read_b64_tr_b16 v[74:75], v16 offset:22528
    ds_read_b64_tr_b16 v[76:77], v17 offset:20480
    ds_read_b64_tr_b16 v[78:79], v17 offset:22528
    ds_read_b64_tr_b16 v[80:81], v16 offset:24576
    ds_read_b64_tr_b16 v[82:83], v16 offset:26624
    ds_read_b64_tr_b16 v[84:85], v17 offset:24576
    ds_read_b64_tr_b16 v[86:87], v17 offset:26624
    ds_read_b64_tr_b16 v[88:89], v16 offset:28672
    ds_read_b64_tr_b16 v[90:91], v16 offset:30720
    ds_read_b64_tr_b16 v[92:93], v17 offset:28672
    ds_read_b64_tr_b16 v[94:95], v17 offset:30720
    s_waitcnt lgkmcnt(14)
    v_mfma_f32_16x16x32_bf16 v[160:163], v[64:67], v[40:43], v[160:163]
    s_waitcnt lgkmcnt(12)
    v_mfma_f32_16x16x32_bf16 v[164:167], v[68:71], v[40:43], v[164:167]
    s_waitcnt lgkmcnt(10)
    v_mfma_f32_16x16x32_bf16 v[160:163], v[72:75], v[40:43], v[160:163]
    s_waitcnt lgkmcnt(8)
    v_mfma_f32_16x16x32_bf16 v[164:167], v[76:79], v[40:43], v[164:167]
    s_waitcnt lgkmcnt(6)
    v_mfma_f32_16x16x32_bf16 v[160:163], v[80:83], v[40:43], v[160:163]
    s_waitcnt lgkmcnt(4)
    v_mfma_f32_16x16x32_bf16 v[164:167], v[84:87], v[40:43], v[164:167]
    s_waitcnt lgkmcnt(2)
    v_mfma_f32_16x16x32_bf16 v[160:163], v[88:91], v[40:43], v[160:163]
    s_waitcnt lgkmcnt(0)
    v_mfma_f32_16x16x32_bf16 v[164:167], v[92:95], v[40:43], v[164:167]
    v_add_u32 v16, s44, v12
    v_add_u32 v17, s44, v13
    s_add_u32 s44, s44, 65536
    ds_read_b64_tr_b16 v[64:65], v16 offset:0
    ds_read_b64_tr_b16 v[66:67], v16 offset:2048
    ds_read_b64_tr_b16 v[68:69], v17 offset:0
    ds_read_b64_tr_b16 v[70:71], v17 offset:2048
    ds_read_b64_tr_b16 v[72:73], v16 offset:4096
    ds_read_b64_tr_b16 v[74:75], v16 offset:6144
    ds_read_b64_tr_b16 v[76:77], v17 offset:4096
    ds_read_b64_tr_b16 v[78:79], v17 offset:6144
    ds_read_b64_tr_b16 v[80:81], v16 offset:8192
    ds_read_b64_tr_b16 v[82:83], v16 offset:10240
    ds_read_b64_tr_b16 v[84:85], v17 offset:8192
    ds_read_b64_tr_b16 v[86:87], v17 offset:10240
    ds_read_b64_tr_b16 v[88:89], v16 offset:12288
    ds_read_b64_tr_b16 v[90:91], v16 offset:14336
    ds_read_b64_tr_b16 v[92:93], v17 offset:12288
    ds_read_b64_tr_b16 v[94:95], v17 offset:14336
    s_waitcnt lgkmcnt(14)
    v_mfma_f32_16x16x32_bf16 v[160:163], v[64:67], v[40:43], v[160:163]
    s_waitcnt lgkmcnt(12)
    v_mfma_f32_16x16x32_bf16 v[164:167], v[68:71], v[40:43], v[164:167]
    s_waitcnt lgkmcnt(10)
    v_mfma_f32_16x16x32_bf16 v[160:163], v[72:75], v[40:43], v[160:163]
    s_waitcnt lgkmcnt(8)
    v_mfma_f32_16x16x32_bf16 v[164:167], v[76:79], v[40:43], v[164:167]
    s_waitcnt lgkmcnt(6)
    v_mfma_f32_16x16x32_bf16 v[160:163], v[80:83], v[40:43], v[160:163]
    s_waitcnt lgkmcnt(4)
    v_mfma_f32_16x16x32_bf16 v[164:167], v[84:87], v[40:43], v[164:167]
    s_waitcnt lgkmcnt(2)
    v_mfma_f32_16x16x32_bf16 v[160:163], v[88:91], v[40:43], v[160:163]
    s_waitcnt lgkmcnt(0)
    v_mfma_f32_16x16x32_bf16 v[164:167], v[92:95], v[40:43], v[164:167]
    ds_read_b64_tr_b16 v[64:65], v16 offset:16384
    ds_read_b64_tr_b16 v[66:67], v16 offset:18432
    ds_read_b64_tr_b16 v[68:69], v17 offset:16384
    ds_read_b64_tr_b16 v[70:71], v17 offset:18432
    ds_read_b64_tr_b16 v[72:73], v16 offset:20480
    ds_read_b64_tr_b16 v[74:75], v16 offset:22528
    ds_read_b64_tr_b16 v[76:77], v17 offset:20480
    ds_read_b64_tr_b16 v[78:79], v17 offset:22528
    ds_read_b64_tr_b16 v[80:81], v16 offset:24576
    ds_read_b64_tr_b16 v[82:83], v16 offset:26624
    ds_read_b64_tr_b16 v[84:85], v17 offset:24576
    ds_read_b64_tr_b16 v[86:87], v17 offset:26624
    ds_read_b64_tr_b16 v[88:89], v16 offset:28672
    ds_read_b64_tr_b16 v[90:91], v16 offset:30720
    ds_read_b64_tr_b16 v[92:93], v17 offset:28672
    ds_read_b64_tr_b16 v[94:95], v17 offset:30720
    s_waitcnt lgkmcnt(14)
    v_mfma_f32_16x16x32_bf16 v[160:163], v[64:67], v[40:43], v[160:163]
    s_waitcnt lgkmcnt(12)
    v_mfma_f32_16x16x32_bf16 v[164:167], v[68:71], v[40:43], v[164:167]
    s_waitcnt lgkmcnt(10)
    v_mfma_f32_16x16x32_bf16 v[160:163], v[72:75], v[40:43], v[160:163]
    s_waitcnt lgkmcnt(8)
    v_mfma_f32_16x16x32_bf16 v[164:167], v[76:79], v[40:43], v[164:167]
    s_waitcnt lgkmcnt(6)
    v_mfma_f32_16x16x32_bf16 v[160:163], v[80:83], v[40:43], v[160:163]
    s_waitcnt lgkmcnt(4)
    v_mfma_f32_16x16x32_bf16 v[164:167], v[84:87], v[40:43], v[164:167]
    s_waitcnt lgkmcnt(2)
    v_mfma_f32_16x16x32_bf16 v[160:163], v[88:91], v[40:43], v[160:163]
    s_waitcnt lgkmcnt(0)
    v_mfma_f32_16x16x32_bf16 v[164:167], v[92:95], v[40:43], v[164:167]
    s_nop 3
    s_setpc_b64 s[48:49]
L_csh:
    v_add_u32 v16, s44, v20
    s_add_u32 s44, s44, 65536
    ds_read_b64_tr_b16 v[64:65], v16 offset:0
    ds_read_b64_tr_b16 v[66:67], v16 offset:1024
    ds_read_b64_tr_b16 v[68:69], v16 offset:2048
    ds_read_b64_tr_b16 v[70:71], v16 offset:3072
    ds_read_b64_tr_b16 v[72:73], v16 offset:4096
    ds_read_b64_tr_b16 v[74:75], v16 offset:5120
    ds_read_b64_tr_b16 v[76:77], v16 offset:6144
    ds_read_b64_tr_b16 v[78:79], v16 offset:7168
    ds_read_b64_tr_b16 v[80:81], v16 offset:8192
    ds_read_b64_tr_b16 v[82:83], v16 offset:9216
    ds_read_b64_tr_b16 v[84:85], v16 offset:10240
    ds_read_b64_tr_b16 v[86:87], v16 offset:11264
    ds_read_b64_tr_b16 v[88:89], v16 offset:12288
    ds_read_b64_tr_b16 v[90:91], v16 offset:13312
    ds_read_b64_tr_b16 v[92:93], v16 offset:14336
    ds_read_b64_tr_b16 v[94:95], v16 offset:15360
    s_waitcnt lgkmcnt(14)
    v_mfma_f32_16x16x32_bf16 v[160:163], v[64:67], v[40:43], 0
    s_waitcnt lgkmcnt(12)
    v_mfma_f32_16x16x32_bf16 v[160:163], v[68:71], v[40:43], v[160:163]
    s_waitcnt lgkmcnt(10)
    v_mfma_f32_16x16x32_bf16 v[160:163], v[72:75], v[40:43], v[160:163]
    s_waitcnt lgkmcnt(8)
    v_mfma_f32_16x16x32_bf16 v[160:163], v[76:79], v[40:43], v[160:163]
    s_waitcnt lgkmcnt(6)
    v_mfma_f32_16x16x32_bf16 v[160:163], v[80:83], v[40:43], v[160:163]
    s_waitcnt lgkmcnt(4)
    v_mfma_f32_16x16x32_bf16 v[160:163], v[84:87], v[40:43], v[160:163]
    s_waitcnt lgkmcnt(2)
    v_mfma_f32_16x16x32_bf16 v[160:163], v[88:91], v[40:43], v[160:163]
    s_waitcnt lgkmcnt(0)
    v_mfma_f32_16x16x32_bf16 v[160:163], v[92:95], v[40:43], v[160:163]
    v_add_u32 v16, s44, v20
    s_add_u32 s44, s44, 65536
    ds_read_b64_tr_b16 v[64:65], v16 offset:0
    ds_read_b64_tr_b16 v[66:67], v16 offset:1024
    ds_read_b64_tr_b16 v[68:69], v16 offset:2048
    ds_read_b64_tr_b16 v[70:71], v16 offset:3072
    ds_read_b64_tr_b16 v[72:73], v16 offset:4096
    ds_read_b64_tr_b16 v[74:75], v16 offset:5120
    ds_read_b64_tr_b16 v[76:77], v16 offset:6144
    ds_read_b64_tr_b16 v[78:79], v16 offset:7168
    ds_read_b64_tr_b16 v[80:81], v16 offset:8192
    ds_read_b64_tr_b16 v[82:83], v16 offset:9216
    ds_read_b64_tr_b16 v[84:85], v16 offset:10240
    ds_read_b64_tr_b16 v[86:87], v16 offset:11264
    ds_read_b64_tr_b16 v[88:89], v16 offset:12288
    ds_read_b64_tr_b16 v[90:91], v16 offset:13312
    ds_read_b64_tr_b16 v[92:93], v16 offset:14336
    ds_read_b64_tr_b16 v[94:95], v16 offset:15360
    s_waitcnt lgkmcnt(14)
    v_mfma_f32_16x16x32_bf16 v[160:163], v[64:67], v[40:43], v[160:163]
    s_waitcnt lgkmcnt(12)
    v_mfma_f32_16x16x32_bf16 v[160:163], v[68:71], v[40:43], v[160:163]
    s_waitcnt lgkmcnt(10)
    v_mfma_f32_16x16x32_bf16 v[160:163], v[72:75], v[40:43], v[160:163]
    s_waitcnt lgkmcnt(8)
    v_mfma_f32_16x16x32_bf16 v[160:163], v[76:79], v[40:43], v[160:163]
    s_waitcnt lgkmcnt(6)
    v_mfma_f32_16x16x32_bf16 v[160:163], v[80:83], v[40:43], v[160:163]
    s_waitcnt lgkmcnt(4)
    v_mfma_f32_16x16x32_bf16 v[160:163], v[84:87], v[40:43], v[160:163]
    s_waitcnt lgkmcnt(2)
    v_mfma_f32_16x16x32_bf16 v[160:163], v[88:91], v[40:43], v[160:163]
    s_waitcnt lgkmcnt(0)
    v_mfma_f32_16x16x32_bf16 v[160:163], v[92:95], v[40:43], v[160:163]
    s_nop 3
    s_setpc_b64 s[48:49]
L_loader:
    s_setprio 2
    v_lshrrev_b32 v3, 3, v0
    v_bfe_u32 v4, v3, 1, 2
    v_lshlrev_b32 v4, 1, v4
    v_and_b32 v5, 7, v0
    v_xor_b32 v4, v4, v5
    v_lshlrev_b32 v4, 4, v4
    v_mul_u32_u24 v13, 3072, v3
    v_add_u32 v13, v13, v4
    v_lshl_add_u32 v14, v3, 10, v4
    v_mul_u32_u24 v15, 3584, v3
    v_add_u32 v15, v15, v4
    v_lshrrev_b32 v3, 2, v0
    v_bfe_u32 v4, v3, 2, 1
    v_lshlrev_b32 v4, 1, v4
    v_and_b32 v5, 3, v0
    v_xor_b32 v4, v4, v5
    v_mul_u32_u24 v16, 3584, v3
    v_lshl_add_u32 v16, v4, 4, v16
    s_lshl_b32 s46, s38, 7
    s_mul_i32 s83, s38, 448
    s_and_b32 s44, s38, 1
    s_lshl_b32 s45, s44, 6
    s_xor_b32 s44, s44, 1
    s_mul_i32 s44, s44, 384
    s_add_u32 s84, s83, s44
    s_add_u32 s83, s83, s45
    s_waitcnt lgkmcnt(0)
    s_mov_b32 s8, s36
    s_mov_b32 s9, s37
    s_cmp_lg_u32 s67, 0
    s_cbranch_scc1 L_ta_21
    s_mov_b32 s4, s18
    s_mov_b32 s5, s19
    s_mov_b32 s6, 1572864
    s_add_u32 s44, s87, 1024
    buffer_load_dword v128, v39, s[4:7], s44 offen
    s_branch L_tb_22
L_ta_21:
    s_mov_b32 s4, s18
    s_mov_b32 s5, s19
    s_mov_b32 s6, 0
    s_add_u32 s44, s87, 0
    buffer_load_dword v129, v39, s[4:7], s44 offen
L_tb_22:
    s_barrier
    s_mov_b32 s12, s18
    s_mov_b32 s13, s19
    s_mov_b32 s14, 1572864
    v_mov_b32 v12, v13
    s_mov_b32 s82, 24576
    s_mov_b32 s88, 0
    s_mul_i32 s45, s67, 393216
    s_add_u32 m0, s61, 0
    s_add_u32 s81, s46, s45
    s_add_u32 s81, s81, 1024
    s_call_b64 s[48:49], L_iss
    s_add_u32 m0, s61, 16384
    s_add_u32 s81, s46, s45
    s_add_u32 s81, s81, 787456
    s_call_b64 s[48:49], L_iss
    s_sleep 6
    s_cmp_lg_u32 s67, 0
    s_cbranch_scc1 L_ta_23
    s_mov_b32 s4, s18
    s_mov_b32 s5, s19
    s_mov_b32 s6, 1572864
    s_add_u32 s44, s87, 2048
    buffer_load_dword v130, v39, s[4:7], s44 offen
    s_branch L_tb_24
L_ta_23:
    s_mov_b32 s4, s18
    s_mov_b32 s5, s19
    s_mov_b32 s6, 1572864
    s_add_u32 s44, s87, 0
    buffer_load_dword v131, v39, s[4:7], s44 offen
L_tb_24:
    s_barrier
    s_waitcnt vmcnt(1)
    s_barrier
    s_add_u32 m0, s61, 32768
    s_add_u32 s81, s46, s45
    s_add_u32 s81, s81, 2048
    s_call_b64 s[48:49], L_iss
    s_add_u32 m0, s61, 49152
    s_add_u32 s81, s46, s45
    s_add_u32 s81, s81, 788480
    s_call_b64 s[48:49], L_iss
    s_sleep 6
    s_cmp_lg_u32 s67, 0
    s_cbranch_scc1 L_ta_25
    s_mov_b32 s4, s20
    s_mov_b32 s5, s21
    s_mov_b32 s6, 524288
    s_add_u32 s44, s85, 0
    buffer_load_dword v132, v37, s[4:7], s44 offen
    s_branch L_tb_26
L_ta_25:
    s_mov_b32 s4, s24
    s_mov_b32 s5, s25
    s_mov_b32 s6, 524288
    s_add_u32 s44, s85, 0
    buffer_load_dword v133, v37, s[4:7], s44 offen
L_tb_26:
    s_waitcnt vmcnt(1)
    s_barrier
    s_barrier
    s_add_u32 m0, s61, 0
    s_add_u32 s81, s46, s45
    s_call_b64 s[48:49], L_iss
    s_add_u32 m0, s61, 16384
    s_add_u32 s81, s46, s45
    s_add_u32 s81, s81, 786432
    s_call_b64 s[48:49], L_iss
    s_sleep 6
    s_cmp_lg_u32 s67, 0
    s_cbranch_scc1 L_ta_27
    s_mov_b32 s4, s26
    s_mov_b32 s5, s27
    s_mov_b32 s6, 524288
    s_add_u32 s44, s85, 0
    buffer_load_dword v134, v37, s[4:7], s44 offen
    s_branch L_tb_28
L_ta_27:
    s_mov_b32 s4, s28
    s_mov_b32 s5, s29
    s_mov_b32 s6, 1835008
    s_add_u32 s44, s86, 0
    buffer_load_dword v135, v38, s[4:7], s44 offen
L_tb_28:
    s_waitcnt vmcnt(1)
    s_barrier
    s_barrier
    s_barrier
    s_sleep 6
    s_mov_b32 s12, s20
    s_mov_b32 s13, s21
    s_mov_b32 s14, 524288
    v_mov_b32 v12, v14
    s_mov_b32 s82, 8192
    s_mul_i32 s45, s67, 131072
    s_add_u32 m0, s61, 32768
    s_add_u32 s81, s46, s45
    s_call_b64 s[48:49], L_iss
    s_add_u32 m0, s61, 49152
    s_add_u32 s81, s46, s45
    s_add_u32 s81, s81, 262144
    s_call_b64 s[48:49], L_iss
    s_waitcnt vmcnt(0)
    s_barrier
    s_mov_b32 s12, s24
    s_mov_b32 s13, s25
    s_mov_b32 s14, 524288
    s_add_u32 m0, s61, 0
    s_add_u32 s81, s46, s45
    s_call_b64 s[48:49], L_iss
    s_add_u32 m0, s61, 16384
    s_add_u32 s81, s46, s45
    s_add_u32 s81, s81, 262144
    s_call_b64 s[48:49], L_iss
    s_sleep 30
    s_cmp_lg_u32 s67, 0
    s_cbranch_scc1 L_ta_29
    s_mov_b32 s4, s28
    s_mov_b32 s5, s29
    s_mov_b32 s6, 1835008
    s_add_u32 s44, s86, 458752
    buffer_load_dword v136, v38, s[4:7], s44 offen
    s_branch L_tb_30
L_ta_29:
    s_mov_b32 s4, s28
    s_mov_b32 s5, s29
    s_mov_b32 s6, 1835008
    s_add_u32 s44, s86, 917504
    buffer_load_dword v137, v38, s[4:7], s44 offen
L_tb_30:
    s_waitcnt vmcnt(1)
    s_barrier
    s_mov_b32 s12, s26
    s_mov_b32 s13, s27
    s_mov_b32 s14, 524288
    s_add_u32 m0, s61, 32768
    s_add_u32 s81, s46, s45
    s_call_b64 s[48:49], L_iss
    s_add_u32 m0, s61, 49152
    s_add_u32 s81, s46, s45
    s_add_u32 s81, s81, 262144
    s_call_b64 s[48:49], L_iss
    s_sleep 30
    s_cmp_lg_u32 s67, 0
    s_cbranch_scc1 L_ta_31
    s_mov_b32 s4, s28
    s_mov_b32 s5, s29
    s_mov_b32 s6, 1835008
    s_add_u32 s44, s86, 1376256
    buffer_load_dword v138, v38, s[4:7], s44 offen
    s_branch L_tb_32
L_ta_31:
    s_mov_b32 s4, s30
    s_mov_b32 s5, s31
    s_mov_b32 s6, 1835008
    s_add_u32 s44, s85, 0
    buffer_load_dword v139, v37, s[4:7], s44 offen
L_tb_32:
    s_waitcnt vmcnt(1)
    s_barrier
    s_mov_b32 s12, s28
    s_mov_b32 s13, s29
    s_mov_b32 s14, 1835008
    v_mov_b32 v12, v15
    s_mov_b32 s82, 28672
    s_mul_i32 s45, s67, 458752
    s_add_u32 m0, s61, 0
    s_add_u32 s81, s83, s45
    s_call_b64 s[48:49], L_iss
    s_add_u32 m0, s61, 16384
    s_add_u32 s81, s83, s45
    s_add_u32 s81, s81, 917504
    s_call_b64 s[48:49], L_iss
    s_sleep 30
    s_cmp_lg_u32 s67, 0
    s_cbranch_scc1 L_ta_33
    s_mov_b32 s4, s30
    s_mov_b32 s5, s31
    s_mov_b32 s6, 1835008
    s_add_u32 s44, s85, 524288
    buffer_load_dword v140, v37, s[4:7], s44 offen
    s_branch L_tb_34
L_ta_33:
    s_mov_b32 s4, s30
    s_mov_b32 s5, s31
    s_mov_b32 s6, 1835008
    s_add_u32 s44, s85, 1048576
    buffer_load_dword v141, v37, s[4:7], s44 offen
L_tb_34:
    s_waitcnt vmcnt(1)
    s_barrier
    s_add_u32 m0, s61, 32768
    s_add_u32 s81, s83, s45
    s_add_u32 s81, s81, 128
    s_call_b64 s[48:49], L_iss
    s_add_u32 m0, s61, 49152
    s_add_u32 s81, s83, s45
    s_add_u32 s81, s81, 917632
    s_call_b64 s[48:49], L_iss
    s_waitcnt vmcnt(0)
    s_barrier
    s_add_u32 m0, s61, 0
    s_add_u32 s81, s83, s45
    s_add_u32 s81, s81, 256
    s_call_b64 s[48:49], L_iss
    s_add_u32 m0, s61, 16384
    s_add_u32 s81, s83, s45
    s_add_u32 s81, s81, 917760
    s_call_b64 s[48:49], L_iss
    s_sleep 6
    s_cmp_lg_u32 s67, 0
    s_cbranch_scc1 L_ta_35
    s_mov_b32 s4, s30
    s_mov_b32 s5, s31
    s_mov_b32 s6, 1835008
    s_add_u32 s44, s85, 1572864
    buffer_load_dword v142, v37, s[4:7], s44 offen
    s_branch L_tb_36
L_ta_35:
    s_mov_b32 s4, s30
    s_mov_b32 s5, s31
    s_mov_b32 s6, 0
    s_add_u32 s44, s85, 0
    buffer_load_dword v143, v37, s[4:7], s44 offen
L_tb_36:
    s_waitcnt vmcnt(1)
    s_barrier
    v_mov_b32 v12, v16
    s_mov_b32 s82, 57344
    s_mov_b32 s88, 458752
    s_add_u32 m0, s61, 32768
    s_add_u32 s81, s84, s45
    s_call_b64 s[48:49], L_iss
    s_mov_b32 s12, s30
    s_mov_b32 s13, s31
    s_mov_b32 s14, 1835008
    v_mov_b32 v12, v14
    s_mov_b32 s82, 8192
    s_mov_b32 s88, 196608
    s_add_u32 m0, s61, 49152
    s_add_u32 s81, s46, s45
    s_call_b64 s[48:49], L_iss
    s_waitcnt vmcnt(16)
    s_barrier
    s_add_u32 m0, s61, 0
    s_add_u32 s81, s46, s45
    s_add_u32 s81, s81, 917504
    s_call_b64 s[48:49], L_iss
    s_add_u32 m0, s61, 16384
    s_add_u32 s81, s46, s45
    s_add_u32 s81, s81, 65536
    s_call_b64 s[48:49], L_iss
    s_waitcnt vmcnt(32)
    s_barrier
    s_add_u32 m0, s61, 32768
    s_add_u32 s81, s46, s45
    s_add_u32 s81, s81, 983040
    s_call_b64 s[48:49], L_iss
    s_waitcnt vmcnt(32)
    s_barrier
    s_waitcnt vmcnt(16)
    s_barrier
    s_add_u32 m0, s61, 49152
    s_add_u32 s81, s46, s45
    s_add_u32 s81, s81, 131072
    s_call_b64 s[48:49], L_iss
    s_waitcnt vmcnt(16)
    s_barrier
    s_add_u32 m0, s61, 0
    s_add_u32 s81, s46, s45
    s_add_u32 s81, s81, 1048576
    s_call_b64 s[48:49], L_iss
    s_waitcnt vmcnt(16)
    s_barrier
    s_mov_b32 s88, 393216
    s_mul_i32 s45, s67, 917504
    s_add_u32 m0, s61, 16384
    s_add_u32 s81, s46, s45
    s_add_u32 s81, s81, 196608
    s_call_b64 s[48:49], L_iss
    s_waitcnt vmcnt(16)
    s_barrier
    s_waitcnt vmcnt(0)
    s_barrier
    s_endpgm
L_iss:
    buffer_load_dwordx4 v12, s[12:15], s81 offen lds
    s_add_u32 m0, m0, 1024
    s_add_u32 s81, s81, s82
    buffer_load_dwordx4 v12, s[12:15], s81 offen lds
    s_add_u32 m0, m0, 1024
    s_add_u32 s81, s81, s82
    buffer_load_dwordx4 v12, s[12:15], s81 offen lds
    s_add_u32 m0, m0, 1024
    s_add_u32 s81, s81, s82
    buffer_load_dwordx4 v12, s[12:15], s81 offen lds
    s_add_u32 m0, m0, 1024
    s_add_u32 s81, s81, s82
    buffer_load_dwordx4 v12, s[12:15], s81 offen lds
    s_add_u32 m0, m0, 1024
    s_add_u32 s81, s81, s82
    buffer_load_dwordx4 v12, s[12:15], s81 offen lds
    s_add_u32 m0, m0, 1024
    s_add_u32 s81, s81, s82
    buffer_load_dwordx4 v12, s[12:15], s81 offen lds
    s_add_u32 m0, m0, 1024
    s_add_u32 s81, s81, s82
    buffer_load_dwordx4 v12, s[12:15], s81 offen lds
    s_add_u32 m0, m0, 1024
    s_add_u32 s81, s81, s82
    s_add_u32 s81, s81, s88
    buffer_load_dwordx4 v12, s[12:15], s81 offen lds
    s_add_u32 m0, m0, 1024
    s_add_u32 s81, s81, s82
    buffer_load_dwordx4 v12, s[12:15], s81 offen lds
    s_add_u32 m0, m0, 1024
    s_add_u32 s81, s81, s82
    buffer_load_dwordx4 v12, s[12:15], s81 offen lds
    s_add_u32 m0, m0, 1024
    s_add_u32 s81, s81, s82
    buffer_load_dwordx4 v12, s[12:15], s81 offen lds
    s_add_u32 m0, m0, 1024
    s_add_u32 s81, s81, s82
    buffer_load_dwordx4 v12, s[12:15], s81 offen lds
    s_add_u32 m0, m0, 1024
    s_add_u32 s81, s81, s82
    buffer_load_dwordx4 v12, s[12:15], s81 offen lds
    s_add_u32 m0, m0, 1024
    s_add_u32 s81, s81, s82
    buffer_load_dwordx4 v12, s[12:15], s81 offen lds
    s_add_u32 m0, m0, 1024
    s_add_u32 s81, s81, s82
    buffer_load_dwordx4 v12, s[12:15], s81 offen lds
    s_setpc_b64 s[48:49]
L_kv_1_s:
    s_sub_u32 s42, s42, 1
    s_cbranch_scc0 L_kv_1
    s_mov_b32 s42, 0
    s_branch L_kv_1_d
L_vv_2_s:
    s_sub_u32 s42, s42, 1
    s_cbranch_scc0 L_vv_2
    s_mov_b32 s42, 0
    s_branch L_vv_2_d
L_rdy_3_s:
    s_sub_u32 s42, s42, 1
    s_cbranch_scc0 L_rdy_3
    s_mov_b32 s42, 0
    s_branch L_rdy_3_d
L_rdy_4_s:
    s_sub_u32 s42, s42, 1
    s_cbranch_scc0 L_rdy_4
    s_mov_b32 s42, 0
    s_branch L_rdy_4_d
L_rdy_5_s:
    s_sub_u32 s42, s42, 1
    s_cbranch_scc0 L_rdy_5
    s_mov_b32 s42, 0
    s_branch L_rdy_5_d
L_rdy_6_s:
    s_sub_u32 s42, s42, 1
    s_cbranch_scc0 L_rdy_6
    s_mov_b32 s42, 0
    s_branch L_rdy_6_d
L_rdy_7_s:
    s_sub_u32 s42, s42, 1
    s_cbranch_scc0 L_rdy_7
    s_mov_b32 s42, 0
    s_branch L_rdy_7_d
L_rdy_9_s:
    s_sub_u32 s42, s42, 1
    s_cbranch_scc0 L_rdy_9
    s_mov_b32 s42, 0
    s_branch L_rdy_9_d
L_rdy_10_s:
    s_sub_u32 s42, s42, 1
    s_cbranch_scc0 L_rdy_10
    s_mov_b32 s42, 0
    s_branch L_rdy_10_d
L_rdy_11_s:
    s_sub_u32 s42, s42, 1
    s_cbranch_scc0 L_rdy_11
    s_mov_b32 s42, 0
    s_branch L_rdy_11_d
L_rdy_12_s:
    s_sub_u32 s42, s42, 1
    s_cbranch_scc0 L_rdy_12
    s_mov_b32 s42, 0
    s_branch L_rdy_12_d
L_rdy_13_s:
    s_sub_u32 s42, s42, 1
    s_cbranch_scc0 L_rdy_13
    s_mov_b32 s42, 0
    s_branch L_rdy_13_d
L_in_loop_s:
    s_sub_u32 s42, s42, 1
    s_cbranch_scc0 L_in_loop
    s_mov_b32 s42, 0
    s_branch L_in_d
L_hf_18_l_s:
    s_sub_u32 s42, s42, 1
    s_cbranch_scc0 L_hf_18_l
    s_mov_b32 s42, 0
    s_branch L_hf_18_d
L_hf_19_l_s:
    s_sub_u32 s42, s42, 1
    s_cbranch_scc0 L_hf_19_l
    s_mov_b32 s42, 0
    s_branch L_hf_19_d
L_ak_20_s:
    s_sub_u32 s42, s42, 1
    s_cbranch_scc0 L_ak_20
    s_mov_b32 s42, 0
    s_branch L_ak_20_d
L_end:
    s_endpgm
.section .rodata,"a"
.p2align 6
.amdhsa_kernel sequential_preLN__sliding_local_dilated__mixer_s_mlp__prompt_kernel
  .amdhsa_next_free_vgpr 256
  .amdhsa_next_free_sgpr 100
  .amdhsa_accum_offset 256
  .amdhsa_group_segment_fixed_size 0
  .amdhsa_kernarg_size 88
  .amdhsa_user_sgpr_count 2
  .amdhsa_user_sgpr_kernarg_segment_ptr 1
  .amdhsa_system_sgpr_workgroup_id_x 1
.end_amdhsa_kernel
```
